```python
import torch

def _softmax(x, axis=-1):
    return torch.softmax(x, dim=axis)
def _gelu(x):
    return torch.nn.functional.gelu(x, approximate="tanh")
def _silu(x):
    return torch.nn.functional.silu(x)
def _sigmoid(x):
    return torch.sigmoid(x)
def _layernorm(x, axis=-1, eps=1e-5):
    m = x.mean(dim=axis, keepdim=True)
    v = x.var(dim=axis, keepdim=True, unbiased=False)
    return (x - m) / torch.sqrt(v + eps)
def _scatter_add(tgt, idx, src, axis=0):
    return tgt.clone().index_add_(axis, idx, src)
def _segment_sum(src, seg, n):
    out = torch.zeros((n,) + src.shape[1:], dtype=src.dtype)
    return out.index_add_(0, seg, src)
def _pad(x, pw):
    flat = tuple(v for pair in reversed(pw) for v in pair)
    return torch.nn.functional.pad(x, flat)

kernel_name = 'standalone__detection_seg_fpn_lateral__vision'

def setup_inputs():

    _w = (lambda a: (lambda t: t.to(torch.bfloat16) if t.is_floating_point() else t)(torch.as_tensor(a)))
    H = W = (224 // 2) * 2
    C = 96
    k = 3
    return {
        "c_fine": _w((lambda *s: torch.randn(*s, dtype=torch.bfloat16) * 0.05)(1, H, W, C)),
        "p_coarse": _w((lambda *s: torch.randn(*s, dtype=torch.bfloat16) * 0.05)(1, H // 2, W // 2, C)),
        "w_lat": _w((lambda *s: torch.randn(*s, dtype=torch.bfloat16) * 0.05)(C, C)),
        "w_out": _w((lambda *s: torch.randn(*s, dtype=torch.bfloat16) * 0.05)(k, k, C, C)),
    }

def reference(c_fine, p_coarse, w_lat, w_out):
    B, H, W, C = c_fine.shape
    k = 3
    lat = torch.einsum("bhwc,cd->bhwd", c_fine, w_lat)
    up = (lambda x, n, axis: torch.repeat_interleave(x, n, dim=axis))((lambda x, n, axis: torch.repeat_interleave(x, n, dim=axis))(p_coarse, 2, axis=1), 2, axis=2)
    m = lat + up
    pad = k // 2
    mp = _pad(m, ((0, 0), (pad, pad), (pad, pad), (0, 0)))
    o = None
    for di in range(k):
        for dj in range(k):
            t = torch.einsum("bhwc,cd->bhwd", mp[:, di:di + H, dj:dj + W, :], w_out[di, dj])
            o = t if o is None else o + t
    return o
```

```asm
; @launch grid=(256,1,1) block=(256,1,1) lds=153600
.amdgcn_target "amdgcn-amd-amdhsa--gfx950"
.text
.globl standalone__detection_seg_fpn_lateral__vision_kernel
.p2align 8
.type standalone__detection_seg_fpn_lateral__vision_kernel,@function
standalone__detection_seg_fpn_lateral__vision_kernel:
    s_cmpk_ge_u32 s2, 256
    s_cbranch_scc1 L_end
    s_load_dwordx8 s[4:11], s[0:1], 0
    s_load_dwordx2 s[12:13], s[0:1], 32
    v_lshrrev_b32 v24, 6, v0
    v_and_b32 v1, 63, v0
    v_readfirstlane_b32 s40, v24
    s_lshr_b32 s19, s2, 3
    s_mov_b32 s98, s19
    s_and_b32 s49, s2, 7
    s_lshl_b32 s49, s49, 1
    s_and_b32 s50, s19, 1
    s_add_u32 s43, s49, s50
    s_lshr_b32 s49, s2, 4
    s_mulk_i32 s19, 5248
    s_mul_i32 s41, s49, 14
    s_mul_i32 s42, s43, 14
    s_lshr_b32 s45, s40, 1
    s_and_b32 s46, s40, 1
    s_mul_i32 s2, s45, -2
    s_add_u32 s2, s2, 1
    s_mul_i32 s55, s45, 15
    s_add_u32 s55, s55, s42
    s_sub_u32 s55, s55, 1
    s_lshr_b32 s56, s42, 1
    s_lshl_b32 s48, s45, 3
    s_add_u32 s56, s56, s48
    s_sub_u32 s56, s56, 1
    s_mulk_i32 s56, 21504
    s_mov_b32 s59, s2
    s_mulk_i32 s59, 21504
    s_lshl_b32 s15, s2, 11
    s_lshl_b32 s14, s45, 4
    s_add_u32 s14, s14, s46
    s_add_u32 s14, s14, 60
    s_lshl_b32 s14, s14, 10
    v_mov_b32 v29, 0x40000000
    v_lshlrev_b32 v32, 4, v1
    v_and_b32 v25, 32, v1
    v_xor_b32 v33, v25, v32
    v_xor_b32 v34, 32, v32
    v_lshlrev_b32 v36, 7, v1
    s_sub_u32 s48, s41, 1
    s_movk_i32 s47, 192
    v_and_b32 v24, 15, v1
    v_lshrrev_b32 v25, 4, v1
    v_add_u32 v27, s48, v24
    v_cmp_gt_u32 vcc, 224, v27
    v_mul_u32_u24 v28, s47, v27
    v_lshl_add_u32 v28, v25, 4, v28
    v_cndmask_b32 v30, v29, v28, vcc
    s_cmp_eq_u32 s49, 0
    s_cselect_b32 s48, s47, 0
    s_cmp_eq_u32 s49, 15
    s_cselect_b32 s50, s47, s48
    s_sub_u32 s50, 1728, s50
    s_lshl_b32 s52, s46, 10
    s_sub_u32 s52, s52, s48
    v_add_u32 v26, s52, v32
    v_cmp_gt_u32 vcc, s50, v26
    s_mulk_i32 s49, 1344
    s_add_u32 s49, s49, s48
    s_sub_u32 s49, s49, s47
    v_add_u32 v26, s49, v26
    v_cndmask_b32 v31, v29, v26, vcc
    s_mov_b32 s23, 0x20000
    s_mov_b32 s22, 9633792
    s_mov_b32 s26, 2408448
    s_movk_i32 s30, 18432
    s_mov_b32 s34, 165888
    s_mov_b32 s27, s23
    s_mov_b32 s31, s23
    s_mov_b32 s35, s23
    s_mov_b32 s50, s40
    s_mulk_i32 s50, 6144
    s_waitcnt lgkmcnt(0)
    s_mov_b64 s[28:29], s[8:9]
    s_mov_b64 s[32:33], s[10:11]
    s_mov_b64 s[20:21], s[4:5]
    s_mov_b64 s[24:25], s[6:7]
    s_cmp_lt_u32 s40, 3
    s_cbranch_scc0 Lelse_1
    s_add_u32 m0, s50, 79872
    s_nop 0
    buffer_load_dwordx4 v32, s[28:31], s50 offen offset:0 lds
    buffer_load_dwordx4 v33, s[28:31], s50 offen offset:1024 lds
    buffer_load_dwordx4 v34, s[28:31], s50 offen offset:2048 lds
    s_add_u32 m0, s50, 82944
    s_addk_i32 s50, 3072
    buffer_load_dwordx4 v32, s[28:31], s50 offen offset:0 lds
    buffer_load_dwordx4 v33, s[28:31], s50 offen offset:1024 lds
    buffer_load_dwordx4 v34, s[28:31], s50 offen offset:2048 lds
    s_branch Ljoin_2
Lelse_1:
    s_mov_b32 exec_hi, 0x1ff
    buffer_load_dword v37, v36, s[32:35], s19 offen
    s_mov_b32 exec_hi, -1
Ljoin_2:
    s_mul_i32 s48, s15, 2
    s_add_u32 m0, s14, s48
    s_mul_i32 s47, s59, 2
    s_add_u32 s47, s47, s56
    buffer_load_dwordx4 v31, s[24:27], s47 offen nt lds
    s_add_u32 s51, s46, 3
    s_mul_i32 s51, s51, s2
    s_add_u32 s51, s51, s55
    s_mul_i32 s51, s51, 43008
    buffer_load_dwordx4 a[144:147], v30, s[20:23], s51 offen offset:0 nt
    buffer_load_dwordx4 a[148:151], v30, s[20:23], s51 offen offset:64 nt
    buffer_load_dwordx4 a[152:155], v30, s[20:23], s51 offen offset:128 nt
    s_mul_i32 s48, s15, 3
    s_add_u32 m0, s14, s48
    s_mul_i32 s47, s59, 3
    s_add_u32 s47, s47, s56
    buffer_load_dwordx4 v31, s[24:27], s47 offen nt lds
    s_getpc_b64 s[96:97]
L_pc:
    s_mulk_i32 s98, 384
    s_min_u32 s98, s98, L_end-L_pc-320
    s_add_u32 s96, s96, s98
    s_addc_u32 s97, s97, 0
    s_load_dword s99, s[96:97], 0
    s_load_dword s99, s[96:97], 64
    s_load_dword s99, s[96:97], 128
    s_load_dword s99, s[96:97], 192
    s_load_dword s99, s[96:97], 256
    s_load_dword s99, s[96:97], 320
    s_mul_i32 s50, s46, 3072
    v_add_u32 v21, s50, v32
    v_add_u32 v22, s50, v33
    v_add_u32 v23, s50, v34
    s_mul_i32 s18, s45, 6144
    s_mul_i32 s54, s45, 18432
    s_add_u32 s54, s54, s50
    s_add_u32 s54, s54, 79872
    s_add_u32 m0, s54, 36864
    s_add_u32 s49, s18, 0
    buffer_load_dwordx4 v21, s[32:35], s49 offen lds
    buffer_load_dwordx4 v22, s[32:35], s49 offen offset:1024 lds
    buffer_load_dwordx4 v23, s[32:35], s49 offen offset:2048 lds
    v_lshrrev_b32 v26, 2, v24
    v_lshl_add_u32 v26, v25, 3, v26
    v_mul_u32_u24 v26, 192, v26
    v_and_b32 v27, 3, v1
    v_and_b32 v28, 1, v25
    v_lshlrev_b32 v28, 5, v28
    v_lshlrev_b32 v18, 4, v27
    v_xor_b32 v18, v18, v28
    v_add_u32 v18, v18, v26
    v_add_u32 v18, 79872, v18
    v_lshl_add_u32 v26, v27, 3, v26
    s_mul_i32 s47, s46, 96
    s_add_u32 s47, s47, 79872
    v_add_u32 v26, s47, v26
    s_mul_i32 s47, s46, -2
    s_add_u32 s47, s47, 1
    v_mul_i32_i24 v28, s47, v28
    v_add_u32 v27, v26, v28
    v_sub_u32 v26, v26, v28
    s_mul_i32 s47, s45, 12288
    s_sub_u32 s48, 12288, s47
    v_add_u32 v12, s47, v27
    v_add_u32 v13, 6144, v27
    v_add_u32 v14, s48, v27
    v_add_u32 v15, s47, v26
    v_add_u32 v16, 6144, v26
    v_add_u32 v17, s48, v26
    v_mul_u32_u24 v2, 224, v24
    v_lshl_add_u32 v2, v25, 4, v2
    s_mul_i32 s3, s45, 53760
    s_mul_i32 s48, s2, 3584
    v_add_u32 v3, s3, v2
    v_add_u32 v4, s48, v3
    v_add_u32 v5, s48, v4
    v_add_u32 v6, s48, v5
    v_add_u32 v7, s48, v6
    v_add_u32 v8, s48, v7
    v_add_u32 v9, s48, v8
    v_add_u32 v10, s48, v9
    v_add_u32 v11, s48, v10
    s_cmp_eq_u32 s46, 1
    s_cselect_b64 s[52:53], -1, 0
    v_cndmask_b32 v172, v6, v7, s[52:53]
    v_cndmask_b32 v173, v8, v9, s[52:53]
    v_cndmask_b32 v174, v4, v5, s[52:53]
    v_cndmask_b32 v175, v10, v3, s[52:53]
    v_cmp_lt_u32 vcc, 13, v24
    v_add_u32 v26, 57344, v2
    v_mov_b32 v40, 0
    v_mov_b32 v41, 0
    v_mov_b32 v42, 0
    v_mov_b32 v43, 0
    v_cndmask_b32 v3, v3, v26, vcc
    v_cndmask_b32 v4, v4, v26, vcc
    v_cndmask_b32 v5, v5, v26, vcc
    v_cndmask_b32 v6, v6, v26, vcc
    v_cndmask_b32 v7, v7, v26, vcc
    v_cndmask_b32 v8, v8, v26, vcc
    v_cndmask_b32 v9, v9, v26, vcc
    v_cndmask_b32 v10, v10, v26, vcc
    v_cndmask_b32 v11, v11, v26, vcc
    ds_write_b128 v32, v[40:43] offset:60480
    v_add_u32 v26, 1, v24
    v_lshrrev_b32 v26, 1, v26
    v_mul_u32_u24 v26, 192, v26
    v_lshl_add_u32 v26, v25, 4, v26
    s_lshl_b32 s47, s45, 14
    s_add_u32 s47, s47, 61440
    v_add_u32 v19, s47, v26
    s_mul_i32 s47, s15, 2
    v_add_u32 v176, s47, v19
    s_mul_i32 s47, s15, 3
    v_add_u32 v177, s47, v19
    s_mul_i32 s47, s15, 1
    v_add_u32 v178, s47, v19
    s_mul_i32 s47, s15, 4
    s_cmp_eq_u32 s46, 1
    s_cselect_b32 s47, 0, s47
    v_add_u32 v179, s47, v19
    v_mul_u32_u24 v26, 208, v24
    s_mul_i32 s47, s46, 96
    s_mul_i32 s48, s45, 23296
    s_add_u32 s48, s48, 79872
    s_add_u32 s47, s47, s48
    v_add_u32 v26, s47, v26
    v_and_b32 v27, 1, v25
    v_lshrrev_b32 v28, 1, v25
    v_lshl_add_u32 v20, v25, 3, v26
    v_lshl_add_u32 v26, v27, 5, v26
    v_lshl_add_u32 v0, v28, 4, v26
    s_lshl_b32 s47, s46, 6
    s_mul_i32 s49, s46, 24
    s_add_u32 s49, s49, 128
    s_mul_i32 s50, s41, 192
    v_add_u32 v26, s47, v1
    v_mul_u32_u24 v27, 5462, v26
    v_lshrrev_b32 v27, 16, v27
    v_lshlrev_b32 v26, 4, v26
    v_lshl_add_u32 v27, v27, 4, v26
    v_add_u32 v180, s48, v27
    v_add_u32 v182, s50, v26
    v_add_u32 v26, s49, v1
    v_mul_u32_u24 v27, 5462, v26
    v_lshrrev_b32 v27, 16, v27
    v_lshlrev_b32 v26, 4, v26
    v_lshl_add_u32 v27, v27, 4, v26
    v_add_u32 v181, s48, v27
    v_add_u32 v183, s50, v26
    s_lshl_b32 s47, s46, 3
    s_sub_u32 s47, 24, s47
    v_cmp_gt_u32 vcc, s47, v1
    s_nop 1
    v_cndmask_b32 v183, v29, v183, vcc
    v_cndmask_b32 v181, v180, v181, vcc
    s_mul_i32 s47, s45, 13
    s_add_u32 s47, s47, s42
    s_mul_i32 s57, s47, 43008
    s_mul_i32 s58, s2, 43008
    s_mov_b64 s[36:37], s[12:13]
    s_mov_b32 s38, 9633792
    s_mov_b32 s39, 0x20000
    s_waitcnt vmcnt(8)
    s_barrier
    ds_read_b64_tr_b16 v[184:185], v18 offset:0
    ds_read_b64_tr_b16 v[186:187], v18 offset:768
    ds_read_b64_tr_b16 v[196:197], v18 offset:8
    ds_read_b64_tr_b16 v[198:199], v18 offset:776
    ds_read_b64_tr_b16 v[208:209], v18 offset:64
    ds_read_b64_tr_b16 v[210:211], v18 offset:832
    s_add_u32 m0, s54, 43008
    s_add_u32 s49, s18, 55296
    buffer_load_dwordx4 v21, s[32:35], s49 offen lds
    ds_read_b64_tr_b16 v[220:221], v18 offset:72
    ds_read_b64_tr_b16 v[222:223], v18 offset:840
    ds_read_b64_tr_b16 v[232:233], v18 offset:128
    ds_read_b64_tr_b16 v[234:235], v18 offset:896
    ds_read_b64_tr_b16 v[244:245], v18 offset:136
    ds_read_b64_tr_b16 v[246:247], v18 offset:904
    buffer_load_dwordx4 v22, s[32:35], s49 offen offset:1024 lds
    ds_read_b64_tr_b16 v[188:189], v18 offset:6144
    ds_read_b64_tr_b16 v[190:191], v18 offset:6912
    s_waitcnt lgkmcnt(14)
    ds_read_b64_tr_b16 v[200:201], v18 offset:6152
    s_waitcnt lgkmcnt(14)
    ds_read_b64_tr_b16 v[202:203], v18 offset:6920
    s_waitcnt lgkmcnt(14)
    ds_read_b64_tr_b16 v[212:213], v18 offset:6208
    s_waitcnt lgkmcnt(14)
    ds_read_b64_tr_b16 v[214:215], v18 offset:6976
    buffer_load_dwordx4 v23, s[32:35], s49 offen offset:2048 lds
    s_waitcnt lgkmcnt(14)
    ds_read_b64_tr_b16 v[224:225], v18 offset:6216
    s_waitcnt lgkmcnt(14)
    ds_read_b64_tr_b16 v[226:227], v18 offset:6984
    s_waitcnt lgkmcnt(14)
    ds_read_b64_tr_b16 v[236:237], v18 offset:6272
    s_waitcnt lgkmcnt(14)
    ds_read_b64_tr_b16 v[238:239], v18 offset:7040
    s_waitcnt lgkmcnt(14)
    ds_read_b64_tr_b16 v[248:249], v18 offset:6280
    s_waitcnt lgkmcnt(14)
    ds_read_b64_tr_b16 v[250:251], v18 offset:7048
    s_add_u32 m0, s54, 49152
    s_add_u32 s49, s18, 110592
    buffer_load_dwordx4 v21, s[32:35], s49 offen lds
    s_waitcnt lgkmcnt(14)
    ds_read_b64_tr_b16 v[192:193], v18 offset:12288
    s_waitcnt lgkmcnt(14)
    ds_read_b64_tr_b16 v[194:195], v18 offset:13056
    s_waitcnt lgkmcnt(14)
    ds_read_b64_tr_b16 v[204:205], v18 offset:12296
    s_waitcnt lgkmcnt(14)
    ds_read_b64_tr_b16 v[206:207], v18 offset:13064
    s_waitcnt lgkmcnt(14)
    ds_read_b64_tr_b16 v[216:217], v18 offset:12352
    s_waitcnt lgkmcnt(14)
    ds_read_b64_tr_b16 v[218:219], v18 offset:13120
    buffer_load_dwordx4 v22, s[32:35], s49 offen offset:1024 lds
    s_waitcnt lgkmcnt(14)
    ds_read_b64_tr_b16 v[228:229], v18 offset:12360
    s_waitcnt lgkmcnt(14)
    ds_read_b64_tr_b16 v[230:231], v18 offset:13128
    s_waitcnt lgkmcnt(14)
    ds_read_b64_tr_b16 v[240:241], v18 offset:12416
    s_waitcnt lgkmcnt(14)
    ds_read_b64_tr_b16 v[242:243], v18 offset:13184
    s_waitcnt lgkmcnt(14)
    ds_read_b64_tr_b16 v[252:253], v18 offset:12424
    s_waitcnt lgkmcnt(14)
    ds_read_b64_tr_b16 v[254:255], v18 offset:13192
    buffer_load_dwordx4 v23, s[32:35], s49 offen offset:2048 lds
    s_waitcnt vmcnt(13)
    s_waitcnt lgkmcnt(0)
    s_barrier
    ds_read_b128 v[152:155], v176 offset:0
    ds_read_b128 v[160:163], v176 offset:64
    ds_read_b128 v[168:171], v176 offset:128
    s_add_u32 s51, s46, 5
    s_mul_i32 s51, s51, s2
    s_add_u32 s51, s51, s55
    s_mul_i32 s51, s51, 43008
    buffer_load_dwordx4 a[216:219], v30, s[20:23], s51 offen offset:0 nt
    buffer_load_dwordx4 a[220:223], v30, s[20:23], s51 offen offset:64 nt
    buffer_load_dwordx4 a[224:227], v30, s[20:23], s51 offen offset:128 nt
    s_waitcnt lgkmcnt(2)
    v_lshlrev_b32 v148, 16, v152
    v_and_b32 v149, 0xffff0000, v152
    v_lshlrev_b32 v150, 16, v153
    v_and_b32 v151, 0xffff0000, v153
    v_lshlrev_b32 v152, 16, v154
    v_and_b32 v153, 0xffff0000, v154
    v_lshlrev_b32 v154, 16, v155
    v_and_b32 v155, 0xffff0000, v155
    s_waitcnt lgkmcnt(1)
    v_lshlrev_b32 v156, 16, v160
    v_and_b32 v157, 0xffff0000, v160
    v_lshlrev_b32 v158, 16, v161
    v_and_b32 v159, 0xffff0000, v161
    v_lshlrev_b32 v160, 16, v162
    v_and_b32 v161, 0xffff0000, v162
    v_lshlrev_b32 v162, 16, v163
    v_and_b32 v163, 0xffff0000, v163
    s_waitcnt lgkmcnt(0)
    v_lshlrev_b32 v164, 16, v168
    v_and_b32 v165, 0xffff0000, v168
    v_lshlrev_b32 v166, 16, v169
    v_and_b32 v167, 0xffff0000, v169
    v_lshlrev_b32 v168, 16, v170
    v_and_b32 v169, 0xffff0000, v170
    v_lshlrev_b32 v170, 16, v171
    v_and_b32 v171, 0xffff0000, v171
    s_waitcnt vmcnt(15)
    v_mfma_f32_16x16x32_bf16 v[148:151], v[184:187], a[144:147], v[148:151]
    v_mfma_f32_16x16x32_bf16 v[152:155], v[196:199], a[144:147], v[152:155]
    v_mfma_f32_16x16x32_bf16 v[156:159], v[208:211], a[144:147], v[156:159]
    v_mfma_f32_16x16x32_bf16 v[160:163], v[220:223], a[144:147], v[160:163]
    v_mfma_f32_16x16x32_bf16 v[164:167], v[232:235], a[144:147], v[164:167]
    v_mfma_f32_16x16x32_bf16 v[168:171], v[244:247], a[144:147], v[168:171]
    s_waitcnt vmcnt(14)
    v_mfma_f32_16x16x32_bf16 v[148:151], v[188:191], a[148:151], v[148:151]
    v_mfma_f32_16x16x32_bf16 v[152:155], v[200:203], a[148:151], v[152:155]
    v_mfma_f32_16x16x32_bf16 v[156:159], v[212:215], a[148:151], v[156:159]
    v_mfma_f32_16x16x32_bf16 v[160:163], v[224:227], a[148:151], v[160:163]
    v_mfma_f32_16x16x32_bf16 v[164:167], v[236:239], a[148:151], v[164:167]
    v_mfma_f32_16x16x32_bf16 v[168:171], v[248:251], a[148:151], v[168:171]
    s_waitcnt vmcnt(13)
    v_mfma_f32_16x16x32_bf16 v[148:151], v[192:195], a[152:155], v[148:151]
    v_mfma_f32_16x16x32_bf16 v[152:155], v[204:207], a[152:155], v[152:155]
    v_mfma_f32_16x16x32_bf16 v[156:159], v[216:219], a[152:155], v[156:159]
    v_mfma_f32_16x16x32_bf16 v[160:163], v[228:231], a[152:155], v[160:163]
    v_mfma_f32_16x16x32_bf16 v[164:167], v[240:243], a[152:155], v[164:167]
    v_mfma_f32_16x16x32_bf16 v[168:171], v[252:255], a[152:155], v[168:171]
    s_add_u32 m0, s54, 0
    s_add_u32 s49, s18, 12288
    buffer_load_dwordx4 v21, s[32:35], s49 offen lds
    buffer_load_dwordx4 v22, s[32:35], s49 offen offset:1024 lds
    buffer_load_dwordx4 v23, s[32:35], s49 offen offset:2048 lds
    v_cvt_pk_bf16_f32 v148, v148, v149
    v_cvt_pk_bf16_f32 v149, v150, v151
    v_cvt_pk_bf16_f32 v150, v152, v153
    v_cvt_pk_bf16_f32 v151, v154, v155
    ds_write_b128 v172, v[148:151] offset:0
    v_cvt_pk_bf16_f32 v156, v156, v157
    v_cvt_pk_bf16_f32 v157, v158, v159
    v_cvt_pk_bf16_f32 v158, v160, v161
    v_cvt_pk_bf16_f32 v159, v162, v163
    ds_write_b128 v172, v[156:159] offset:64
    v_cvt_pk_bf16_f32 v164, v164, v165
    v_cvt_pk_bf16_f32 v165, v166, v167
    v_cvt_pk_bf16_f32 v166, v168, v169
    v_cvt_pk_bf16_f32 v167, v170, v171
    ds_write_b128 v172, v[164:167] offset:128
    s_waitcnt vmcnt(6)
    s_waitcnt lgkmcnt(0)
    s_barrier
    ds_read_b128 v[32:35], v6 offset:0
    ds_read_b128 v[36:39], v7 offset:0
    ds_read_b64_tr_b16 a[24:25], v14 offset:36864
    ds_read_b64_tr_b16 a[26:27], v14 offset:37632
    ds_read_b64_tr_b16 a[28:29], v17 offset:36896
    ds_read_b64_tr_b16 a[30:31], v17 offset:37664
    ds_read_b64_tr_b16 a[32:33], v14 offset:36928
    ds_read_b64_tr_b16 a[34:35], v14 offset:37696
    s_waitcnt lgkmcnt(4)
    v_mfma_f32_16x16x32_bf16 v[76:79], a[24:27], v[32:35], 0
    ds_read_b64_tr_b16 a[12:13], v13 offset:36864
    ds_read_b64_tr_b16 a[14:15], v13 offset:37632
    s_waitcnt lgkmcnt(4)
    v_mfma_f32_16x16x32_bf16 v[80:83], a[28:31], v[32:35], 0
    ds_read_b64_tr_b16 a[16:17], v16 offset:36896
    ds_read_b64_tr_b16 a[18:19], v16 offset:37664
    s_waitcnt lgkmcnt(4)
    v_mfma_f32_16x16x32_bf16 v[84:87], a[32:35], v[32:35], 0
    ds_read_b64_tr_b16 a[20:21], v13 offset:36928
    ds_read_b64_tr_b16 a[22:23], v13 offset:37696
    v_mfma_f32_16x16x32_bf16 v[88:91], a[24:27], v[36:39], 0
    ds_read_b64_tr_b16 a[0:1], v12 offset:36864
    ds_read_b64_tr_b16 a[2:3], v12 offset:37632
    v_mfma_f32_16x16x32_bf16 v[92:95], a[28:31], v[36:39], 0
    ds_read_b64_tr_b16 a[4:5], v15 offset:36896
    ds_read_b64_tr_b16 a[6:7], v15 offset:37664
    v_mfma_f32_16x16x32_bf16 v[96:99], a[32:35], v[36:39], 0
    ds_read_b64_tr_b16 a[8:9], v12 offset:36928
    ds_read_b64_tr_b16 a[10:11], v12 offset:37696
    s_waitcnt lgkmcnt(10)
    v_mfma_f32_16x16x32_bf16 v[88:91], a[12:15], v[32:35], v[88:91]
    ds_read_b128 v[152:155], v177 offset:0
    ds_read_b128 v[160:163], v177 offset:64
    s_waitcnt lgkmcnt(10)
    v_mfma_f32_16x16x32_bf16 v[92:95], a[16:19], v[32:35], v[92:95]
    ds_read_b128 v[168:171], v177 offset:128
    ds_read_b128 v[40:43], v6 offset:64
    s_waitcnt lgkmcnt(10)
    v_mfma_f32_16x16x32_bf16 v[96:99], a[20:23], v[32:35], v[96:99]
    ds_read_b128 v[44:47], v7 offset:64
    v_mfma_f32_16x16x32_bf16 v[100:103], a[12:15], v[36:39], 0
    ds_read_b64_tr_b16 a[60:61], v14 offset:55296
    s_add_u32 m0, s54, 6144
    s_add_u32 s49, s18, 67584
    buffer_load_dwordx4 v21, s[32:35], s49 offen lds
    v_mfma_f32_16x16x32_bf16 v[104:107], a[16:19], v[36:39], 0
    ds_read_b64_tr_b16 a[62:63], v14 offset:56064
    ds_read_b64_tr_b16 a[64:65], v17 offset:55328
    v_mfma_f32_16x16x32_bf16 v[108:111], a[20:23], v[36:39], 0
    ds_read_b64_tr_b16 a[66:67], v17 offset:56096
    s_waitcnt lgkmcnt(13)
    v_mfma_f32_16x16x32_bf16 v[100:103], a[0:3], v[32:35], v[100:103]
    ds_read_b64_tr_b16 a[68:69], v14 offset:55360
    ds_read_b64_tr_b16 a[70:71], v14 offset:56128
    s_waitcnt lgkmcnt(13)
    v_mfma_f32_16x16x32_bf16 v[104:107], a[4:7], v[32:35], v[104:107]
    ds_read_b64_tr_b16 a[48:49], v13 offset:55296
    buffer_load_dwordx4 v22, s[32:35], s49 offen offset:1024 lds
    s_waitcnt lgkmcnt(12)
    v_mfma_f32_16x16x32_bf16 v[108:111], a[8:11], v[32:35], v[108:111]
    ds_read_b64_tr_b16 a[50:51], v13 offset:56064
    v_mfma_f32_16x16x32_bf16 v[112:115], a[0:3], v[36:39], 0
    ds_read_b64_tr_b16 a[52:53], v16 offset:55328
    ds_read_b64_tr_b16 a[54:55], v16 offset:56096
    v_mfma_f32_16x16x32_bf16 v[116:119], a[4:7], v[36:39], 0
    s_waitcnt lgkmcnt(14)
    ds_read_b64_tr_b16 a[56:57], v13 offset:55360
    s_waitcnt lgkmcnt(14)
    ds_read_b64_tr_b16 a[58:59], v13 offset:56128
    v_mfma_f32_16x16x32_bf16 v[120:123], a[8:11], v[36:39], 0
    buffer_load_dwordx4 v23, s[32:35], s49 offen offset:2048 lds
    s_waitcnt lgkmcnt(10)
    v_mfma_f32_16x16x32_bf16 v[76:79], a[60:63], v[40:43], v[76:79]
    ds_read_b64_tr_b16 a[36:37], v12 offset:55296
    ds_read_b64_tr_b16 a[38:39], v12 offset:56064
    s_add_u32 m0, s54, 12288
    s_add_u32 s49, s18, 122880
    buffer_load_dwordx4 v21, s[32:35], s49 offen lds
    s_waitcnt lgkmcnt(10)
    v_mfma_f32_16x16x32_bf16 v[80:83], a[64:67], v[40:43], v[80:83]
    ds_read_b64_tr_b16 a[40:41], v15 offset:55328
    ds_read_b64_tr_b16 a[42:43], v15 offset:56096
    s_waitcnt lgkmcnt(10)
    v_mfma_f32_16x16x32_bf16 v[84:87], a[68:71], v[40:43], v[84:87]
    buffer_load_dwordx4 v22, s[32:35], s49 offen offset:1024 lds
    ds_read_b64_tr_b16 a[44:45], v12 offset:55360
    s_waitcnt lgkmcnt(9)
    v_mfma_f32_16x16x32_bf16 v[88:91], a[48:51], v[40:43], v[88:91]
    ds_read_b64_tr_b16 a[46:47], v12 offset:56128
    buffer_load_dwordx4 v23, s[32:35], s49 offen offset:2048 lds
    s_waitcnt lgkmcnt(8)
    v_mfma_f32_16x16x32_bf16 v[92:95], a[52:55], v[40:43], v[92:95]
    v_lshlrev_b32 v148, 16, v152
    v_and_b32 v149, 0xffff0000, v152
    s_waitcnt lgkmcnt(6)
    v_mfma_f32_16x16x32_bf16 v[96:99], a[56:59], v[40:43], v[96:99]
    v_lshlrev_b32 v150, 16, v153
    v_and_b32 v151, 0xffff0000, v153
    s_waitcnt lgkmcnt(4)
    v_mfma_f32_16x16x32_bf16 v[100:103], a[36:39], v[40:43], v[100:103]
    v_lshlrev_b32 v152, 16, v154
    v_and_b32 v153, 0xffff0000, v154
    v_lshlrev_b32 v154, 16, v155
    s_waitcnt lgkmcnt(2)
    v_mfma_f32_16x16x32_bf16 v[104:107], a[40:43], v[40:43], v[104:107]
    v_and_b32 v155, 0xffff0000, v155
    v_lshlrev_b32 v156, 16, v160
    v_and_b32 v157, 0xffff0000, v160
    s_waitcnt lgkmcnt(0)
    v_mfma_f32_16x16x32_bf16 v[108:111], a[44:47], v[40:43], v[108:111]
    v_lshlrev_b32 v158, 16, v161
    v_and_b32 v159, 0xffff0000, v161
    v_lshlrev_b32 v160, 16, v162
    v_and_b32 v161, 0xffff0000, v162
    v_lshlrev_b32 v162, 16, v163
    v_and_b32 v163, 0xffff0000, v163
    v_lshlrev_b32 v164, 16, v168
    v_and_b32 v165, 0xffff0000, v168
    v_lshlrev_b32 v166, 16, v169
    v_and_b32 v167, 0xffff0000, v169
    v_lshlrev_b32 v168, 16, v170
    v_and_b32 v169, 0xffff0000, v170
    v_lshlrev_b32 v170, 16, v171
    v_and_b32 v171, 0xffff0000, v171
    s_mul_i32 s48, s15, 1
    s_add_u32 m0, s14, s48
    s_mul_i32 s47, s59, 1
    s_add_u32 s47, s47, s56
    buffer_load_dwordx4 v31, s[24:27], s47 offen nt lds
    s_add_u32 s51, s46, 1
    s_mul_i32 s51, s51, s2
    s_add_u32 s51, s51, s55
    s_mul_i32 s51, s51, 43008
    buffer_load_dwordx4 a[228:231], v30, s[20:23], s51 offen offset:0 nt
    buffer_load_dwordx4 a[232:235], v30, s[20:23], s51 offen offset:64 nt
    buffer_load_dwordx4 a[236:239], v30, s[20:23], s51 offen offset:128 nt
    s_waitcnt vmcnt(15)
    v_mfma_f32_16x16x32_bf16 v[148:151], v[184:187], a[216:219], v[148:151]
    v_mfma_f32_16x16x32_bf16 v[152:155], v[196:199], a[216:219], v[152:155]
    v_mfma_f32_16x16x32_bf16 v[156:159], v[208:211], a[216:219], v[156:159]
    v_mfma_f32_16x16x32_bf16 v[160:163], v[220:223], a[216:219], v[160:163]
    v_mfma_f32_16x16x32_bf16 v[164:167], v[232:235], a[216:219], v[164:167]
    v_mfma_f32_16x16x32_bf16 v[168:171], v[244:247], a[216:219], v[168:171]
    s_waitcnt vmcnt(14)
    v_mfma_f32_16x16x32_bf16 v[148:151], v[188:191], a[220:223], v[148:151]
    v_mfma_f32_16x16x32_bf16 v[152:155], v[200:203], a[220:223], v[152:155]
    v_mfma_f32_16x16x32_bf16 v[156:159], v[212:215], a[220:223], v[156:159]
    v_mfma_f32_16x16x32_bf16 v[160:163], v[224:227], a[220:223], v[160:163]
    v_mfma_f32_16x16x32_bf16 v[164:167], v[236:239], a[220:223], v[164:167]
    v_mfma_f32_16x16x32_bf16 v[168:171], v[248:251], a[220:223], v[168:171]
    s_waitcnt vmcnt(13)
    v_mfma_f32_16x16x32_bf16 v[148:151], v[192:195], a[224:227], v[148:151]
    v_mfma_f32_16x16x32_bf16 v[152:155], v[204:207], a[224:227], v[152:155]
    v_mfma_f32_16x16x32_bf16 v[156:159], v[216:219], a[224:227], v[156:159]
    v_mfma_f32_16x16x32_bf16 v[160:163], v[228:231], a[224:227], v[160:163]
    v_mfma_f32_16x16x32_bf16 v[164:167], v[240:243], a[224:227], v[164:167]
    v_mfma_f32_16x16x32_bf16 v[168:171], v[252:255], a[224:227], v[168:171]
    v_mfma_f32_16x16x32_bf16 v[88:91], a[60:63], v[44:47], v[88:91]
    s_nop 1
    v_cvt_pk_bf16_f32 v148, v148, v149
    v_cvt_pk_bf16_f32 v149, v150, v151
    v_mfma_f32_16x16x32_bf16 v[92:95], a[64:67], v[44:47], v[92:95]
    v_cvt_pk_bf16_f32 v150, v152, v153
    v_cvt_pk_bf16_f32 v151, v154, v155
    v_mfma_f32_16x16x32_bf16 v[96:99], a[68:71], v[44:47], v[96:99]
    ds_write_b128 v173, v[148:151] offset:0
    v_mfma_f32_16x16x32_bf16 v[100:103], a[48:51], v[44:47], v[100:103]
    v_cvt_pk_bf16_f32 v156, v156, v157
    v_cvt_pk_bf16_f32 v157, v158, v159
    v_mfma_f32_16x16x32_bf16 v[104:107], a[52:55], v[44:47], v[104:107]
    v_cvt_pk_bf16_f32 v158, v160, v161
    v_cvt_pk_bf16_f32 v159, v162, v163
    v_mfma_f32_16x16x32_bf16 v[108:111], a[56:59], v[44:47], v[108:111]
    ds_write_b128 v173, v[156:159] offset:64
    v_mfma_f32_16x16x32_bf16 v[112:115], a[36:39], v[44:47], v[112:115]
    v_cvt_pk_bf16_f32 v164, v164, v165
    v_cvt_pk_bf16_f32 v165, v166, v167
    v_mfma_f32_16x16x32_bf16 v[116:119], a[40:43], v[44:47], v[116:119]
    v_cvt_pk_bf16_f32 v166, v168, v169
    v_cvt_pk_bf16_f32 v167, v170, v171
    v_mfma_f32_16x16x32_bf16 v[120:123], a[44:47], v[44:47], v[120:123]
    ds_write_b128 v173, v[164:167] offset:128
    s_waitcnt vmcnt(4)
    s_waitcnt lgkmcnt(0)
    s_barrier
    ds_read_b128 v[48:51], v8 offset:0
    ds_read_b128 v[52:55], v9 offset:0
    ds_read_b128 v[56:59], v8 offset:64
    ds_read_b128 v[60:63], v9 offset:64
    s_waitcnt lgkmcnt(3)
    v_mfma_f32_16x16x32_bf16 v[100:103], a[24:27], v[48:51], v[100:103]
    ds_read_b128 v[32:35], v6 offset:128
    s_waitcnt lgkmcnt(2)
    v_mfma_f32_16x16x32_bf16 v[100:103], a[60:63], v[56:59], v[100:103]
    ds_read_b128 v[36:39], v7 offset:128
    v_mfma_f32_16x16x32_bf16 v[104:107], a[28:31], v[48:51], v[104:107]
    ds_read_b128 v[40:43], v8 offset:128
    v_mfma_f32_16x16x32_bf16 v[104:107], a[64:67], v[56:59], v[104:107]
    ds_read_b128 v[44:47], v9 offset:128
    v_mfma_f32_16x16x32_bf16 v[108:111], a[32:35], v[48:51], v[108:111]
    ds_read_b64_tr_b16 a[96:97], v14 offset:0
    v_mfma_f32_16x16x32_bf16 v[108:111], a[68:71], v[56:59], v[108:111]
    ds_read_b64_tr_b16 a[98:99], v14 offset:768
    v_mfma_f32_16x16x32_bf16 v[112:115], a[12:15], v[48:51], v[112:115]
    ds_read_b64_tr_b16 a[100:101], v17 offset:32
    v_mfma_f32_16x16x32_bf16 v[112:115], a[24:27], v[52:55], v[112:115]
    ds_read_b64_tr_b16 a[102:103], v17 offset:800
    v_mfma_f32_16x16x32_bf16 v[112:115], a[48:51], v[56:59], v[112:115]
    ds_read_b64_tr_b16 a[104:105], v14 offset:64
    s_waitcnt lgkmcnt(9)
    v_mfma_f32_16x16x32_bf16 v[112:115], a[60:63], v[60:63], v[112:115]
    ds_read_b64_tr_b16 a[106:107], v14 offset:832
    s_mul_i32 s48, s15, 4
    s_add_u32 m0, s14, s48
    s_mul_i32 s47, s59, 4
    s_add_u32 s47, s47, s56
    buffer_load_dwordx4 v31, s[24:27], s47 offen nt lds
    v_mfma_f32_16x16x32_bf16 v[116:119], a[16:19], v[48:51], v[116:119]
    ds_read_b64_tr_b16 a[84:85], v13 offset:0
    v_mfma_f32_16x16x32_bf16 v[116:119], a[28:31], v[52:55], v[116:119]
    ds_read_b64_tr_b16 a[86:87], v13 offset:768
    v_mfma_f32_16x16x32_bf16 v[116:119], a[52:55], v[56:59], v[116:119]
    ds_read_b64_tr_b16 a[88:89], v16 offset:32
    v_mfma_f32_16x16x32_bf16 v[116:119], a[64:67], v[60:63], v[116:119]
    ds_read_b64_tr_b16 a[90:91], v16 offset:800
    v_mfma_f32_16x16x32_bf16 v[120:123], a[20:23], v[48:51], v[120:123]
    ds_read_b64_tr_b16 a[92:93], v13 offset:64
    s_mov_b32 m0, s14
    s_mul_i32 s48, s45, 15
    s_cmp_eq_u32 s43, s48
    s_cselect_b32 s26, 0, 2408448
    s_cselect_b32 s47, 0, s56
    buffer_load_dwordx4 v31, s[24:27], s47 offen nt lds
    s_mov_b32 s26, 2408448
    v_mfma_f32_16x16x32_bf16 v[120:123], a[32:35], v[52:55], v[120:123]
    s_waitcnt lgkmcnt(7)
    ds_read_b64_tr_b16 a[94:95], v13 offset:832
    v_mfma_f32_16x16x32_bf16 v[120:123], a[56:59], v[56:59], v[120:123]
    ds_read_b64_tr_b16 a[72:73], v12 offset:0
    v_mfma_f32_16x16x32_bf16 v[120:123], a[68:71], v[60:63], v[120:123]
    ds_read_b64_tr_b16 a[74:75], v12 offset:768
    v_mfma_f32_16x16x32_bf16 v[124:127], a[0:3], v[48:51], 0
    ds_read_b64_tr_b16 a[76:77], v15 offset:32
    v_mfma_f32_16x16x32_bf16 v[124:127], a[12:15], v[52:55], v[124:127]
    ds_read_b64_tr_b16 a[78:79], v15 offset:800
    v_mfma_f32_16x16x32_bf16 v[124:127], a[36:39], v[56:59], v[124:127]
    s_mul_i32 s51, s46, -7
    s_add_u32 s51, s51, 7
    s_mul_i32 s51, s51, s2
    s_add_u32 s51, s51, s55
    s_cmp_ge_u32 s51, 224
    s_cselect_b32 s22, 0, 9633792
    s_cselect_b32 s51, 0, s51
    s_mul_i32 s51, s51, 43008
    buffer_load_dwordx4 a[240:243], v30, s[20:23], s51 offen offset:0 nt
    v_mfma_f32_16x16x32_bf16 v[124:127], a[48:51], v[60:63], v[124:127]
    v_mfma_f32_16x16x32_bf16 v[128:131], a[4:7], v[48:51], 0
    ds_read_b64_tr_b16 a[80:81], v12 offset:64
    v_mfma_f32_16x16x32_bf16 v[128:131], a[16:19], v[52:55], v[128:131]
    ds_read_b64_tr_b16 a[82:83], v12 offset:832
    v_mfma_f32_16x16x32_bf16 v[128:131], a[40:43], v[56:59], v[128:131]
    ds_read_b64_tr_b16 a[132:133], v14 offset:18432
    v_mfma_f32_16x16x32_bf16 v[128:131], a[52:55], v[60:63], v[128:131]
    s_waitcnt lgkmcnt(7)
    ds_read_b64_tr_b16 a[134:135], v14 offset:19200
    v_mfma_f32_16x16x32_bf16 v[132:135], a[8:11], v[48:51], 0
    ds_read_b64_tr_b16 a[136:137], v17 offset:18464
    v_mfma_f32_16x16x32_bf16 v[132:135], a[20:23], v[52:55], v[132:135]
    buffer_load_dwordx4 a[244:247], v30, s[20:23], s51 offen offset:64 nt
    v_mfma_f32_16x16x32_bf16 v[132:135], a[44:47], v[56:59], v[132:135]
    v_mfma_f32_16x16x32_bf16 v[132:135], a[56:59], v[60:63], v[132:135]
    ds_read_b64_tr_b16 a[138:139], v17 offset:19232
    v_mfma_f32_16x16x32_bf16 v[136:139], a[0:3], v[52:55], 0
    ds_read_b64_tr_b16 a[140:141], v14 offset:18496
    v_mfma_f32_16x16x32_bf16 v[136:139], a[36:39], v[60:63], v[136:139]
    ds_read_b64_tr_b16 a[142:143], v14 offset:19264
    v_mfma_f32_16x16x32_bf16 v[140:143], a[4:7], v[52:55], 0
    ds_read_b64_tr_b16 a[120:121], v13 offset:18432
    v_mfma_f32_16x16x32_bf16 v[140:143], a[40:43], v[60:63], v[140:143]
    ds_read_b64_tr_b16 a[122:123], v13 offset:19200
    v_mfma_f32_16x16x32_bf16 v[144:147], a[8:11], v[52:55], 0
    buffer_load_dwordx4 a[248:251], v30, s[20:23], s51 offen offset:128 nt
    v_mfma_f32_16x16x32_bf16 v[144:147], a[44:47], v[60:63], v[144:147]
    v_mfma_f32_16x16x32_bf16 v[76:79], a[96:99], v[32:35], v[76:79]
    ds_read_b128 v[48:51], v6 offset:224
    v_mfma_f32_16x16x32_bf16 v[80:83], a[100:103], v[32:35], v[80:83]
    s_waitcnt lgkmcnt(7)
    ds_read_b128 v[52:55], v7 offset:224
    v_mfma_f32_16x16x32_bf16 v[84:87], a[104:107], v[32:35], v[84:87]
    ds_read_b64_tr_b16 a[124:125], v16 offset:18464
    v_mfma_f32_16x16x32_bf16 v[88:91], a[84:87], v[32:35], v[88:91]
    ds_read_b64_tr_b16 a[126:127], v16 offset:19232
    v_mfma_f32_16x16x32_bf16 v[88:91], a[96:99], v[36:39], v[88:91]
    ds_read_b64_tr_b16 a[128:129], v13 offset:18496
    v_mfma_f32_16x16x32_bf16 v[92:95], a[88:91], v[32:35], v[92:95]
    ds_read_b64_tr_b16 a[130:131], v13 offset:19264
    v_mfma_f32_16x16x32_bf16 v[92:95], a[100:103], v[36:39], v[92:95]
    ds_read_b64_tr_b16 a[108:109], v12 offset:18432
    v_mfma_f32_16x16x32_bf16 v[96:99], a[92:95], v[32:35], v[96:99]
    ds_read_b64_tr_b16 a[110:111], v12 offset:19200
    v_mfma_f32_16x16x32_bf16 v[96:99], a[104:107], v[36:39], v[96:99]
    ds_read_b64_tr_b16 a[112:113], v15 offset:18464
    v_mfma_f32_16x16x32_bf16 v[100:103], a[72:75], v[32:35], v[100:103]
    s_waitcnt lgkmcnt(7)
    ds_read_b64_tr_b16 a[114:115], v15 offset:19232
    v_mfma_f32_16x16x32_bf16 v[100:103], a[84:87], v[36:39], v[100:103]
    ds_read_b64_tr_b16 a[116:117], v12 offset:18496
    v_mfma_f32_16x16x32_bf16 v[104:107], a[76:79], v[32:35], v[104:107]
    ds_read_b64_tr_b16 a[118:119], v12 offset:19264
    v_mfma_f32_16x16x32_bf16 v[104:107], a[88:91], v[36:39], v[104:107]
    v_mfma_f32_16x16x32_bf16 v[108:111], a[80:83], v[32:35], v[108:111]
    v_mfma_f32_16x16x32_bf16 v[108:111], a[92:95], v[36:39], v[108:111]
    v_mfma_f32_16x16x32_bf16 v[112:115], a[72:75], v[36:39], v[112:115]
    v_mfma_f32_16x16x32_bf16 v[116:119], a[76:79], v[36:39], v[116:119]
    v_mfma_f32_16x16x32_bf16 v[120:123], a[80:83], v[36:39], v[120:123]
    s_waitcnt vmcnt(5)
    s_waitcnt lgkmcnt(0)
    s_barrier
    v_mfma_f32_16x16x32_bf16 v[100:103], a[96:99], v[40:43], v[100:103]
    ds_read_b128 v[56:59], v8 offset:224
    ds_read_b128 v[152:155], v178 offset:0
    ds_read_b128 v[160:163], v178 offset:64
    v_mfma_f32_16x16x32_bf16 v[104:107], a[100:103], v[40:43], v[104:107]
    ds_read_b128 v[60:63], v9 offset:224
    ds_read_b128 v[168:171], v178 offset:128
    v_mfma_f32_16x16x32_bf16 v[108:111], a[104:107], v[40:43], v[108:111]
    s_waitcnt lgkmcnt(3)
    v_lshlrev_b32 v148, 16, v152
    v_and_b32 v149, 0xffff0000, v152
    v_mfma_f32_16x16x32_bf16 v[112:115], a[84:87], v[40:43], v[112:115]
    v_lshlrev_b32 v150, 16, v153
    v_mfma_f32_16x16x32_bf16 v[112:115], a[96:99], v[44:47], v[112:115]
    v_and_b32 v151, 0xffff0000, v153
    v_lshlrev_b32 v152, 16, v154
    v_mfma_f32_16x16x32_bf16 v[116:119], a[88:91], v[40:43], v[116:119]
    v_and_b32 v153, 0xffff0000, v154
    v_mfma_f32_16x16x32_bf16 v[116:119], a[100:103], v[44:47], v[116:119]
    v_lshlrev_b32 v154, 16, v155
    v_and_b32 v155, 0xffff0000, v155
    v_mfma_f32_16x16x32_bf16 v[120:123], a[92:95], v[40:43], v[120:123]
    s_waitcnt lgkmcnt(2)
    v_lshlrev_b32 v156, 16, v160
    v_mfma_f32_16x16x32_bf16 v[120:123], a[104:107], v[44:47], v[120:123]
    v_and_b32 v157, 0xffff0000, v160
    v_lshlrev_b32 v158, 16, v161
    v_mfma_f32_16x16x32_bf16 v[124:127], a[72:75], v[40:43], v[124:127]
    v_and_b32 v159, 0xffff0000, v161
    v_mfma_f32_16x16x32_bf16 v[124:127], a[84:87], v[44:47], v[124:127]
    v_lshlrev_b32 v160, 16, v162
    v_and_b32 v161, 0xffff0000, v162
    v_mfma_f32_16x16x32_bf16 v[128:131], a[76:79], v[40:43], v[128:131]
    v_lshlrev_b32 v162, 16, v163
    v_mfma_f32_16x16x32_bf16 v[128:131], a[88:91], v[44:47], v[128:131]
    v_and_b32 v163, 0xffff0000, v163
    s_waitcnt lgkmcnt(0)
    v_lshlrev_b32 v164, 16, v168
    v_mfma_f32_16x16x32_bf16 v[132:135], a[80:83], v[40:43], v[132:135]
    v_and_b32 v165, 0xffff0000, v168
    v_mfma_f32_16x16x32_bf16 v[132:135], a[92:95], v[44:47], v[132:135]
    v_lshlrev_b32 v166, 16, v169
    v_and_b32 v167, 0xffff0000, v169
    v_mfma_f32_16x16x32_bf16 v[136:139], a[72:75], v[44:47], v[136:139]
    v_lshlrev_b32 v168, 16, v170
    v_mfma_f32_16x16x32_bf16 v[140:143], a[76:79], v[44:47], v[140:143]
    v_and_b32 v169, 0xffff0000, v170
    v_lshlrev_b32 v170, 16, v171
    v_mfma_f32_16x16x32_bf16 v[144:147], a[80:83], v[44:47], v[144:147]
    v_and_b32 v171, 0xffff0000, v171
    v_mfma_f32_16x16x32_bf16 v[148:151], v[184:187], a[228:231], v[148:151]
    s_add_u32 m0, s54, 36864
    s_add_u32 s49, s18, 24576
    buffer_load_dwordx4 v21, s[32:35], s49 offen lds
    v_mfma_f32_16x16x32_bf16 v[148:151], v[188:191], a[232:235], v[148:151]
    v_mfma_f32_16x16x32_bf16 v[148:151], v[192:195], a[236:239], v[148:151]
    v_mfma_f32_16x16x32_bf16 v[152:155], v[196:199], a[228:231], v[152:155]
    v_mfma_f32_16x16x32_bf16 v[152:155], v[200:203], a[232:235], v[152:155]
    v_mfma_f32_16x16x32_bf16 v[152:155], v[204:207], a[236:239], v[152:155]
    v_mfma_f32_16x16x32_bf16 v[156:159], v[208:211], a[228:231], v[156:159]
    buffer_load_dwordx4 v22, s[32:35], s49 offen offset:1024 lds
    v_mfma_f32_16x16x32_bf16 v[156:159], v[212:215], a[232:235], v[156:159]
    v_mfma_f32_16x16x32_bf16 v[156:159], v[216:219], a[236:239], v[156:159]
    v_mfma_f32_16x16x32_bf16 v[160:163], v[220:223], a[228:231], v[160:163]
    v_mfma_f32_16x16x32_bf16 v[160:163], v[224:227], a[232:235], v[160:163]
    v_mfma_f32_16x16x32_bf16 v[160:163], v[228:231], a[236:239], v[160:163]
    v_mfma_f32_16x16x32_bf16 v[164:167], v[232:235], a[228:231], v[164:167]
    buffer_load_dwordx4 v23, s[32:35], s49 offen offset:2048 lds
    v_mfma_f32_16x16x32_bf16 v[164:167], v[236:239], a[232:235], v[164:167]
    v_mfma_f32_16x16x32_bf16 v[164:167], v[240:243], a[236:239], v[164:167]
    v_mfma_f32_16x16x32_bf16 v[168:171], v[244:247], a[228:231], v[168:171]
    v_mfma_f32_16x16x32_bf16 v[168:171], v[248:251], a[232:235], v[168:171]
    v_mfma_f32_16x16x32_bf16 v[168:171], v[252:255], a[236:239], v[168:171]
    v_mfma_f32_16x16x32_bf16 v[76:79], a[132:135], v[48:51], v[76:79]
    v_cvt_pk_bf16_f32 v148, v148, v149
    v_mfma_f32_16x16x32_bf16 v[80:83], a[136:139], v[48:51], v[80:83]
    v_cvt_pk_bf16_f32 v149, v150, v151
    v_mfma_f32_16x16x32_bf16 v[84:87], a[140:143], v[48:51], v[84:87]
    v_cvt_pk_bf16_f32 v150, v152, v153
    v_mfma_f32_16x16x32_bf16 v[88:91], a[120:123], v[48:51], v[88:91]
    v_cvt_pk_bf16_f32 v151, v154, v155
    v_mfma_f32_16x16x32_bf16 v[88:91], a[132:135], v[52:55], v[88:91]
    ds_write_b128 v174, v[148:151] offset:0
    v_mfma_f32_16x16x32_bf16 v[92:95], a[124:127], v[48:51], v[92:95]
    v_cvt_pk_bf16_f32 v156, v156, v157
    v_mfma_f32_16x16x32_bf16 v[92:95], a[136:139], v[52:55], v[92:95]
    v_cvt_pk_bf16_f32 v157, v158, v159
    v_mfma_f32_16x16x32_bf16 v[96:99], a[128:131], v[48:51], v[96:99]
    v_cvt_pk_bf16_f32 v158, v160, v161
    v_mfma_f32_16x16x32_bf16 v[96:99], a[140:143], v[52:55], v[96:99]
    v_cvt_pk_bf16_f32 v159, v162, v163
    v_mfma_f32_16x16x32_bf16 v[100:103], a[108:111], v[48:51], v[100:103]
    ds_write_b128 v174, v[156:159] offset:64
    v_mfma_f32_16x16x32_bf16 v[100:103], a[120:123], v[52:55], v[100:103]
    v_cvt_pk_bf16_f32 v164, v164, v165
    v_mfma_f32_16x16x32_bf16 v[104:107], a[112:115], v[48:51], v[104:107]
    v_cvt_pk_bf16_f32 v165, v166, v167
    v_mfma_f32_16x16x32_bf16 v[104:107], a[124:127], v[52:55], v[104:107]
    v_cvt_pk_bf16_f32 v166, v168, v169
    v_mfma_f32_16x16x32_bf16 v[108:111], a[116:119], v[48:51], v[108:111]
    v_cvt_pk_bf16_f32 v167, v170, v171
    v_mfma_f32_16x16x32_bf16 v[108:111], a[128:131], v[52:55], v[108:111]
    ds_write_b128 v174, v[164:167] offset:128
    v_mfma_f32_16x16x32_bf16 v[112:115], a[108:111], v[52:55], v[112:115]
    s_add_u32 m0, s54, 43008
    s_add_u32 s49, s18, 79872
    buffer_load_dwordx4 v21, s[32:35], s49 offen lds
    v_mfma_f32_16x16x32_bf16 v[116:119], a[112:115], v[52:55], v[116:119]
    buffer_load_dwordx4 v22, s[32:35], s49 offen offset:1024 lds
    v_mfma_f32_16x16x32_bf16 v[120:123], a[116:119], v[52:55], v[120:123]
    buffer_load_dwordx4 v23, s[32:35], s49 offen offset:2048 lds
    s_waitcnt vmcnt(6)
    s_waitcnt lgkmcnt(0)
    s_barrier
    v_mfma_f32_16x16x32_bf16 v[100:103], a[132:135], v[56:59], v[100:103]
    ds_read_b128 v[32:35], v5 offset:0
    ds_read_b128 v[152:155], v179 offset:0
    ds_read_b128 v[160:163], v179 offset:64
    v_mfma_f32_16x16x32_bf16 v[104:107], a[136:139], v[56:59], v[104:107]
    ds_read_b128 v[36:39], v4 offset:0
    ds_read_b128 v[168:171], v179 offset:128
    s_waitcnt lgkmcnt(3)
    v_lshlrev_b32 v148, 16, v152
    v_mfma_f32_16x16x32_bf16 v[108:111], a[140:143], v[56:59], v[108:111]
    ds_read_b128 v[40:43], v5 offset:64
    v_and_b32 v149, 0xffff0000, v152
    v_mfma_f32_16x16x32_bf16 v[112:115], a[120:123], v[56:59], v[112:115]
    ds_read_b128 v[44:47], v4 offset:64
    v_lshlrev_b32 v150, 16, v153
    v_and_b32 v151, 0xffff0000, v153
    v_mfma_f32_16x16x32_bf16 v[112:115], a[132:135], v[60:63], v[112:115]
    v_lshlrev_b32 v152, 16, v154
    v_and_b32 v153, 0xffff0000, v154
    v_mfma_f32_16x16x32_bf16 v[116:119], a[124:127], v[56:59], v[116:119]
    v_lshlrev_b32 v154, 16, v155
    v_mfma_f32_16x16x32_bf16 v[116:119], a[136:139], v[60:63], v[116:119]
    v_and_b32 v155, 0xffff0000, v155
    s_add_u32 m0, s54, 49152
    s_add_u32 s49, s18, 135168
    buffer_load_dwordx4 v21, s[32:35], s49 offen lds
    v_mfma_f32_16x16x32_bf16 v[120:123], a[128:131], v[56:59], v[120:123]
    s_waitcnt lgkmcnt(4)
    v_lshlrev_b32 v156, 16, v160
    v_and_b32 v157, 0xffff0000, v160
    v_mfma_f32_16x16x32_bf16 v[120:123], a[140:143], v[60:63], v[120:123]
    v_lshlrev_b32 v158, 16, v161
    v_mfma_f32_16x16x32_bf16 v[124:127], a[108:111], v[56:59], v[124:127]
    v_and_b32 v159, 0xffff0000, v161
    v_lshlrev_b32 v160, 16, v162
    v_mfma_f32_16x16x32_bf16 v[124:127], a[120:123], v[60:63], v[124:127]
    v_and_b32 v161, 0xffff0000, v162
    v_lshlrev_b32 v162, 16, v163
    v_mfma_f32_16x16x32_bf16 v[128:131], a[112:115], v[56:59], v[128:131]
    v_and_b32 v163, 0xffff0000, v163
    v_mfma_f32_16x16x32_bf16 v[128:131], a[124:127], v[60:63], v[128:131]
    buffer_load_dwordx4 v22, s[32:35], s49 offen offset:1024 lds
    s_waitcnt lgkmcnt(2)
    v_lshlrev_b32 v164, 16, v168
    v_mfma_f32_16x16x32_bf16 v[132:135], a[116:119], v[56:59], v[132:135]
    v_and_b32 v165, 0xffff0000, v168
    v_lshlrev_b32 v166, 16, v169
    v_mfma_f32_16x16x32_bf16 v[132:135], a[128:131], v[60:63], v[132:135]
    v_and_b32 v167, 0xffff0000, v169
    v_mfma_f32_16x16x32_bf16 v[136:139], a[108:111], v[60:63], v[136:139]
    v_lshlrev_b32 v168, 16, v170
    v_and_b32 v169, 0xffff0000, v170
    v_mfma_f32_16x16x32_bf16 v[140:143], a[112:115], v[60:63], v[140:143]
    v_lshlrev_b32 v170, 16, v171
    v_and_b32 v171, 0xffff0000, v171
    v_mfma_f32_16x16x32_bf16 v[144:147], a[116:119], v[60:63], v[144:147]
    buffer_load_dwordx4 v23, s[32:35], s49 offen offset:2048 lds
    v_mfma_f32_16x16x32_bf16 v[148:151], v[184:187], a[240:243], v[148:151]
    s_add_u32 m0, s54, 0
    s_add_u32 s49, s18, 36864
    buffer_load_dwordx4 v21, s[32:35], s49 offen lds
    v_mfma_f32_16x16x32_bf16 v[148:151], v[188:191], a[244:247], v[148:151]
    v_mfma_f32_16x16x32_bf16 v[148:151], v[192:195], a[248:251], v[148:151]
    v_mfma_f32_16x16x32_bf16 v[152:155], v[196:199], a[240:243], v[152:155]
    v_mfma_f32_16x16x32_bf16 v[152:155], v[200:203], a[244:247], v[152:155]
    buffer_load_dwordx4 v22, s[32:35], s49 offen offset:1024 lds
    v_mfma_f32_16x16x32_bf16 v[152:155], v[204:207], a[248:251], v[152:155]
    v_mfma_f32_16x16x32_bf16 v[156:159], v[208:211], a[240:243], v[156:159]
    v_mfma_f32_16x16x32_bf16 v[156:159], v[212:215], a[244:247], v[156:159]
    v_mfma_f32_16x16x32_bf16 v[156:159], v[216:219], a[248:251], v[156:159]
    v_mfma_f32_16x16x32_bf16 v[160:163], v[220:223], a[240:243], v[160:163]
    buffer_load_dwordx4 v23, s[32:35], s49 offen offset:2048 lds
    v_mfma_f32_16x16x32_bf16 v[160:163], v[224:227], a[244:247], v[160:163]
    v_mfma_f32_16x16x32_bf16 v[160:163], v[228:231], a[248:251], v[160:163]
    v_mfma_f32_16x16x32_bf16 v[164:167], v[232:235], a[240:243], v[164:167]
    v_mfma_f32_16x16x32_bf16 v[164:167], v[236:239], a[244:247], v[164:167]
    s_add_u32 m0, s54, 6144
    s_add_u32 s49, s18, 92160
    buffer_load_dwordx4 v21, s[32:35], s49 offen lds
    v_mfma_f32_16x16x32_bf16 v[164:167], v[240:243], a[248:251], v[164:167]
    v_mfma_f32_16x16x32_bf16 v[168:171], v[244:247], a[240:243], v[168:171]
    v_mfma_f32_16x16x32_bf16 v[168:171], v[248:251], a[244:247], v[168:171]
    v_mfma_f32_16x16x32_bf16 v[168:171], v[252:255], a[248:251], v[168:171]
    v_mfma_f32_16x16x32_bf16 v[64:67], a[24:27], v[32:35], 0
    ds_read_b128 v[48:51], v5 offset:128
    v_cvt_pk_bf16_f32 v148, v148, v149
    v_cvt_pk_bf16_f32 v149, v150, v151
    v_mfma_f32_16x16x32_bf16 v[64:67], a[12:15], v[36:39], v[64:67]
    ds_read_b128 v[52:55], v4 offset:128
    v_cvt_pk_bf16_f32 v150, v152, v153
    v_mfma_f32_16x16x32_bf16 v[68:71], a[28:31], v[32:35], 0
    v_cvt_pk_bf16_f32 v151, v154, v155
    v_mfma_f32_16x16x32_bf16 v[68:71], a[16:19], v[36:39], v[68:71]
    ds_write_b128 v175, v[148:151] offset:0
    v_mfma_f32_16x16x32_bf16 v[72:75], a[32:35], v[32:35], 0
    v_cvt_pk_bf16_f32 v156, v156, v157
    v_mfma_f32_16x16x32_bf16 v[72:75], a[20:23], v[36:39], v[72:75]
    v_cvt_pk_bf16_f32 v157, v158, v159
    v_mfma_f32_16x16x32_bf16 v[76:79], a[12:15], v[32:35], v[76:79]
    v_cvt_pk_bf16_f32 v158, v160, v161
    v_mfma_f32_16x16x32_bf16 v[76:79], a[0:3], v[36:39], v[76:79]
    v_cvt_pk_bf16_f32 v159, v162, v163
    ds_write_b128 v175, v[156:159] offset:64
    v_mfma_f32_16x16x32_bf16 v[80:83], a[16:19], v[32:35], v[80:83]
    v_cvt_pk_bf16_f32 v164, v164, v165
    v_mfma_f32_16x16x32_bf16 v[80:83], a[4:7], v[36:39], v[80:83]
    v_cvt_pk_bf16_f32 v165, v166, v167
    v_mfma_f32_16x16x32_bf16 v[84:87], a[20:23], v[32:35], v[84:87]
    v_cvt_pk_bf16_f32 v166, v168, v169
    v_mfma_f32_16x16x32_bf16 v[84:87], a[8:11], v[36:39], v[84:87]
    v_cvt_pk_bf16_f32 v167, v170, v171
    v_mfma_f32_16x16x32_bf16 v[88:91], a[0:3], v[32:35], v[88:91]
    ds_write_b128 v175, v[164:167] offset:128
    v_mfma_f32_16x16x32_bf16 v[92:95], a[4:7], v[32:35], v[92:95]
    buffer_load_dwordx4 v22, s[32:35], s49 offen offset:1024 lds
    v_mfma_f32_16x16x32_bf16 v[96:99], a[8:11], v[32:35], v[96:99]
    buffer_load_dwordx4 v23, s[32:35], s49 offen offset:2048 lds
    s_waitcnt lgkmcnt(6)
    v_mfma_f32_16x16x32_bf16 v[64:67], a[60:63], v[40:43], v[64:67]
    ds_read_b128 v[56:59], v5 offset:224
    s_add_u32 m0, s54, 12288
    s_add_u32 s49, s18, 147456
    buffer_load_dwordx4 v21, s[32:35], s49 offen lds
    s_waitcnt lgkmcnt(6)
    v_mfma_f32_16x16x32_bf16 v[64:67], a[48:51], v[44:47], v[64:67]
    ds_read_b128 v[60:63], v4 offset:224
    v_mfma_f32_16x16x32_bf16 v[68:71], a[64:67], v[40:43], v[68:71]
    v_mfma_f32_16x16x32_bf16 v[68:71], a[52:55], v[44:47], v[68:71]
    v_mfma_f32_16x16x32_bf16 v[72:75], a[68:71], v[40:43], v[72:75]
    v_mfma_f32_16x16x32_bf16 v[72:75], a[56:59], v[44:47], v[72:75]
    buffer_load_dwordx4 v22, s[32:35], s49 offen offset:1024 lds
    v_mfma_f32_16x16x32_bf16 v[76:79], a[48:51], v[40:43], v[76:79]
    v_mfma_f32_16x16x32_bf16 v[76:79], a[36:39], v[44:47], v[76:79]
    v_mfma_f32_16x16x32_bf16 v[80:83], a[52:55], v[40:43], v[80:83]
    v_mfma_f32_16x16x32_bf16 v[80:83], a[40:43], v[44:47], v[80:83]
    v_mfma_f32_16x16x32_bf16 v[84:87], a[56:59], v[40:43], v[84:87]
    buffer_load_dwordx4 v23, s[32:35], s49 offen offset:2048 lds
    v_mfma_f32_16x16x32_bf16 v[84:87], a[44:47], v[44:47], v[84:87]
    v_mfma_f32_16x16x32_bf16 v[88:91], a[36:39], v[40:43], v[88:91]
    v_mfma_f32_16x16x32_bf16 v[92:95], a[40:43], v[40:43], v[92:95]
    v_mfma_f32_16x16x32_bf16 v[96:99], a[44:47], v[40:43], v[96:99]
    s_waitcnt vmcnt(9)
    s_waitcnt lgkmcnt(0)
    s_barrier
    v_mfma_f32_16x16x32_bf16 v[64:67], a[96:99], v[48:51], v[64:67]
    ds_read_b128 v[32:35], v10 offset:0
    v_mfma_f32_16x16x32_bf16 v[64:67], a[84:87], v[52:55], v[64:67]
    ds_read_b128 v[36:39], v11 offset:0
    v_mfma_f32_16x16x32_bf16 v[64:67], a[132:135], v[56:59], v[64:67]
    ds_read_b128 v[40:43], v3 offset:0
    v_mfma_f32_16x16x32_bf16 v[64:67], a[120:123], v[60:63], v[64:67]
    ds_read_b128 v[44:47], v10 offset:64
    v_mfma_f32_16x16x32_bf16 v[68:71], a[100:103], v[48:51], v[68:71]
    ds_read_b64_tr_b16 a[204:205], v14 offset:55296
    v_mfma_f32_16x16x32_bf16 v[68:71], a[88:91], v[52:55], v[68:71]
    ds_read_b64_tr_b16 a[206:207], v14 offset:56064
    v_mfma_f32_16x16x32_bf16 v[68:71], a[136:139], v[56:59], v[68:71]
    ds_read_b64_tr_b16 a[208:209], v17 offset:55328
    v_mfma_f32_16x16x32_bf16 v[68:71], a[124:127], v[60:63], v[68:71]
    ds_read_b64_tr_b16 a[210:211], v17 offset:56096
    v_mfma_f32_16x16x32_bf16 v[72:75], a[104:107], v[48:51], v[72:75]
    ds_read_b64_tr_b16 a[212:213], v14 offset:55360
    v_mfma_f32_16x16x32_bf16 v[72:75], a[92:95], v[52:55], v[72:75]
    ds_read_b64_tr_b16 a[214:215], v14 offset:56128
    v_mfma_f32_16x16x32_bf16 v[72:75], a[140:143], v[56:59], v[72:75]
    ds_read_b64_tr_b16 a[192:193], v13 offset:55296
    v_mfma_f32_16x16x32_bf16 v[72:75], a[128:131], v[60:63], v[72:75]
    ds_read_b64_tr_b16 a[194:195], v13 offset:56064
    v_mfma_f32_16x16x32_bf16 v[76:79], a[84:87], v[48:51], v[76:79]
    ds_read_b64_tr_b16 a[196:197], v16 offset:55328
    v_mfma_f32_16x16x32_bf16 v[76:79], a[72:75], v[52:55], v[76:79]
    ds_read_b64_tr_b16 a[198:199], v16 offset:56096
    v_mfma_f32_16x16x32_bf16 v[76:79], a[120:123], v[56:59], v[76:79]
    ds_read_b64_tr_b16 a[200:201], v13 offset:55360
    v_mfma_f32_16x16x32_bf16 v[76:79], a[108:111], v[60:63], v[76:79]
    s_waitcnt lgkmcnt(7)
    ds_read_b64_tr_b16 a[202:203], v13 offset:56128
    v_mfma_f32_16x16x32_bf16 v[80:83], a[88:91], v[48:51], v[80:83]
    ds_read_b64_tr_b16 a[180:181], v12 offset:55296
    v_mfma_f32_16x16x32_bf16 v[80:83], a[76:79], v[52:55], v[80:83]
    v_mfma_f32_16x16x32_bf16 v[80:83], a[124:127], v[56:59], v[80:83]
    ds_read_b64_tr_b16 a[182:183], v12 offset:56064
    v_mfma_f32_16x16x32_bf16 v[80:83], a[112:115], v[60:63], v[80:83]
    ds_read_b64_tr_b16 a[184:185], v15 offset:55328
    v_mfma_f32_16x16x32_bf16 v[84:87], a[92:95], v[48:51], v[84:87]
    v_mfma_f32_16x16x32_bf16 v[84:87], a[80:83], v[52:55], v[84:87]
    ds_read_b64_tr_b16 a[186:187], v15 offset:56096
    v_mfma_f32_16x16x32_bf16 v[84:87], a[128:131], v[56:59], v[84:87]
    ds_read_b64_tr_b16 a[188:189], v12 offset:55360
    v_mfma_f32_16x16x32_bf16 v[84:87], a[116:119], v[60:63], v[84:87]
    ds_read_b64_tr_b16 a[190:191], v12 offset:56128
    v_mfma_f32_16x16x32_bf16 v[88:91], a[72:75], v[48:51], v[88:91]
    v_mfma_f32_16x16x32_bf16 v[88:91], a[108:111], v[56:59], v[88:91]
    ds_read_b64_tr_b16 a[144:145], v12 offset:36864
    v_mfma_f32_16x16x32_bf16 v[92:95], a[76:79], v[48:51], v[92:95]
    s_waitcnt lgkmcnt(7)
    ds_read_b64_tr_b16 a[146:147], v12 offset:37632
    v_mfma_f32_16x16x32_bf16 v[92:95], a[112:115], v[56:59], v[92:95]
    v_mfma_f32_16x16x32_bf16 v[96:99], a[80:83], v[48:51], v[96:99]
    ds_read_b64_tr_b16 a[148:149], v15 offset:36896
    v_mfma_f32_16x16x32_bf16 v[96:99], a[116:119], v[56:59], v[96:99]
    ds_read_b64_tr_b16 a[150:151], v15 offset:37664
    v_mfma_f32_16x16x32_bf16 v[64:67], a[0:3], v[40:43], v[64:67]
    ds_read_b128 v[48:51], v11 offset:64
    v_mfma_f32_16x16x32_bf16 v[68:71], a[4:7], v[40:43], v[68:71]
    ds_read_b128 v[52:55], v3 offset:64
    v_mfma_f32_16x16x32_bf16 v[72:75], a[8:11], v[40:43], v[72:75]
    ds_read_b128 v[56:59], v10 offset:128
    v_mfma_f32_16x16x32_bf16 v[124:127], a[24:27], v[32:35], v[124:127]
    ds_read_b64_tr_b16 a[152:153], v12 offset:36928
    v_mfma_f32_16x16x32_bf16 v[128:131], a[28:31], v[32:35], v[128:131]
    ds_read_b64_tr_b16 a[154:155], v12 offset:37696
    v_mfma_f32_16x16x32_bf16 v[132:135], a[32:35], v[32:35], v[132:135]
    s_waitcnt lgkmcnt(7)
    ds_read_b64_tr_b16 a[156:157], v13 offset:36864
    v_mfma_f32_16x16x32_bf16 v[136:139], a[12:15], v[32:35], v[136:139]
    ds_read_b64_tr_b16 a[158:159], v13 offset:37632
    v_mfma_f32_16x16x32_bf16 v[136:139], a[24:27], v[36:39], v[136:139]
    ds_read_b64_tr_b16 a[160:161], v16 offset:36896
    v_mfma_f32_16x16x32_bf16 v[140:143], a[16:19], v[32:35], v[140:143]
    ds_read_b64_tr_b16 a[162:163], v16 offset:37664
    v_mfma_f32_16x16x32_bf16 v[140:143], a[28:31], v[36:39], v[140:143]
    ds_read_b64_tr_b16 a[164:165], v13 offset:36928
    v_mfma_f32_16x16x32_bf16 v[144:147], a[20:23], v[32:35], v[144:147]
    ds_read_b64_tr_b16 a[166:167], v13 offset:37696
    v_mfma_f32_16x16x32_bf16 v[144:147], a[32:35], v[36:39], v[144:147]
    s_waitcnt vmcnt(0)
    s_barrier
    s_waitcnt lgkmcnt(9)
    v_mfma_f32_16x16x32_bf16 v[64:67], a[36:39], v[52:55], v[64:67]
    ds_read_b128 v[60:63], v11 offset:128
    v_mfma_f32_16x16x32_bf16 v[68:71], a[40:43], v[52:55], v[68:71]
    ds_read_b128 v[32:35], v3 offset:128
    v_mfma_f32_16x16x32_bf16 v[72:75], a[44:47], v[52:55], v[72:75]
    ds_read_b128 v[36:39], v10 offset:224
    v_mfma_f32_16x16x32_bf16 v[124:127], a[60:63], v[44:47], v[124:127]
    ds_read_b128 v[40:43], v11 offset:224
    s_waitcnt lgkmcnt(12)
    v_mfma_f32_16x16x32_bf16 v[124:127], a[96:99], v[56:59], v[124:127]
    ds_read_b64_tr_b16 a[168:169], v14 offset:36864
    v_mfma_f32_16x16x32_bf16 v[128:131], a[64:67], v[44:47], v[128:131]
    ds_read_b64_tr_b16 a[170:171], v14 offset:37632
    v_mfma_f32_16x16x32_bf16 v[128:131], a[100:103], v[56:59], v[128:131]
    ds_read_b64_tr_b16 a[172:173], v17 offset:36896
    v_mfma_f32_16x16x32_bf16 v[132:135], a[68:71], v[44:47], v[132:135]
    s_waitcnt lgkmcnt(7)
    ds_read_b64_tr_b16 a[174:175], v17 offset:37664
    v_mfma_f32_16x16x32_bf16 v[132:135], a[104:107], v[56:59], v[132:135]
    ds_read_b64_tr_b16 a[176:177], v14 offset:36928
    v_mfma_f32_16x16x32_bf16 v[136:139], a[48:51], v[44:47], v[136:139]
    ds_read_b64_tr_b16 a[178:179], v14 offset:37696
    s_cmp_eq_u32 s45, 0
    s_cbranch_scc0 Lskip_3
    s_add_u32 m0, s54, 55296
    s_add_u32 s49, s18, 49152
    buffer_load_dwordx4 v21, s[32:35], s49 offen lds
    buffer_load_dwordx4 v22, s[32:35], s49 offen offset:1024 lds
    buffer_load_dwordx4 v23, s[32:35], s49 offen offset:2048 lds
Lskip_3:
    v_mfma_f32_16x16x32_bf16 v[136:139], a[60:63], v[48:51], v[136:139]
    ds_read_b64_tr_b16 a[240:241], v14 offset:0
    v_mfma_f32_16x16x32_bf16 v[136:139], a[84:87], v[56:59], v[136:139]
    ds_read_b64_tr_b16 a[242:243], v14 offset:768
    v_mfma_f32_16x16x32_bf16 v[140:143], a[52:55], v[44:47], v[140:143]
    ds_read_b64_tr_b16 a[244:245], v17 offset:32
    v_mfma_f32_16x16x32_bf16 v[140:143], a[64:67], v[48:51], v[140:143]
    ds_read_b64_tr_b16 a[246:247], v17 offset:800
    v_mfma_f32_16x16x32_bf16 v[140:143], a[88:91], v[56:59], v[140:143]
    ds_read_b64_tr_b16 a[248:249], v14 offset:64
    v_mfma_f32_16x16x32_bf16 v[144:147], a[56:59], v[44:47], v[144:147]
    s_waitcnt lgkmcnt(7)
    ds_read_b64_tr_b16 a[250:251], v14 offset:832
    v_mfma_f32_16x16x32_bf16 v[144:147], a[68:71], v[48:51], v[144:147]
    s_cmp_eq_u32 s45, 0
    s_cbranch_scc0 Lskip_4
    s_add_u32 m0, s54, 61440
    s_add_u32 s49, s18, 104448
    buffer_load_dwordx4 v21, s[32:35], s49 offen lds
    buffer_load_dwordx4 v22, s[32:35], s49 offen offset:1024 lds
    buffer_load_dwordx4 v23, s[32:35], s49 offen offset:2048 lds
Lskip_4:
    v_mfma_f32_16x16x32_bf16 v[144:147], a[92:95], v[56:59], v[144:147]
    v_mfma_f32_16x16x32_bf16 v[64:67], a[72:75], v[32:35], v[64:67]
    ds_read_b128 v[44:47], v3 offset:224
    v_mfma_f32_16x16x32_bf16 v[68:71], a[76:79], v[32:35], v[68:71]
    ds_read_b128 v[48:51], v3 offset:288
    v_mfma_f32_16x16x32_bf16 v[72:75], a[80:83], v[32:35], v[72:75]
    ds_read_b128 v[52:55], v4 offset:288
    v_mfma_f32_16x16x32_bf16 v[124:127], a[132:135], v[36:39], v[124:127]
    ds_read_b128 v[56:59], v3 offset:352
    v_mfma_f32_16x16x32_bf16 v[128:131], a[136:139], v[36:39], v[128:131]
    ds_read_b64_tr_b16 a[228:229], v13 offset:0
    v_mfma_f32_16x16x32_bf16 v[132:135], a[140:143], v[36:39], v[132:135]
    ds_read_b64_tr_b16 a[230:231], v13 offset:768
    v_mfma_f32_16x16x32_bf16 v[136:139], a[96:99], v[60:63], v[136:139]
    ds_read_b64_tr_b16 a[232:233], v16 offset:32
    v_mfma_f32_16x16x32_bf16 v[136:139], a[120:123], v[36:39], v[136:139]
    s_waitcnt lgkmcnt(7)
    ds_read_b64_tr_b16 a[234:235], v16 offset:800
    v_mfma_f32_16x16x32_bf16 v[136:139], a[132:135], v[40:43], v[136:139]
    ds_read_b64_tr_b16 a[236:237], v13 offset:64
    v_mfma_f32_16x16x32_bf16 v[140:143], a[100:103], v[60:63], v[140:143]
    ds_read_b64_tr_b16 a[238:239], v13 offset:832
    s_cmp_eq_u32 s45, 0
    s_cbranch_scc0 Lskip_5
    s_add_u32 m0, s54, 67584
    s_add_u32 s49, s18, 159744
    buffer_load_dwordx4 v21, s[32:35], s49 offen lds
    buffer_load_dwordx4 v22, s[32:35], s49 offen offset:1024 lds
    buffer_load_dwordx4 v23, s[32:35], s49 offen offset:2048 lds
Lskip_5:
    v_mfma_f32_16x16x32_bf16 v[140:143], a[124:127], v[36:39], v[140:143]
    ds_read_b64_tr_b16 a[216:217], v12 offset:0
    v_mfma_f32_16x16x32_bf16 v[140:143], a[136:139], v[40:43], v[140:143]
    ds_read_b64_tr_b16 a[218:219], v12 offset:768
    v_mfma_f32_16x16x32_bf16 v[144:147], a[104:107], v[60:63], v[144:147]
    ds_read_b64_tr_b16 a[220:221], v15 offset:32
    v_mfma_f32_16x16x32_bf16 v[144:147], a[128:131], v[36:39], v[144:147]
    ds_read_b64_tr_b16 a[222:223], v15 offset:800
    v_mfma_f32_16x16x32_bf16 v[144:147], a[140:143], v[40:43], v[144:147]
    ds_read_b64_tr_b16 a[224:225], v12 offset:64
    s_waitcnt lgkmcnt(14)
    v_mfma_f32_16x16x32_bf16 v[64:67], a[108:111], v[44:47], v[64:67]
    ds_read_b128 v[60:63], v4 offset:352
    v_mfma_f32_16x16x32_bf16 v[68:71], a[112:115], v[44:47], v[68:71]
    s_waitcnt lgkmcnt(7)
    ds_read_b64_tr_b16 a[226:227], v12 offset:832
    v_mfma_f32_16x16x32_bf16 v[72:75], a[116:119], v[44:47], v[72:75]
    v_mfma_f32_16x16x32_bf16 v[64:67], a[144:147], v[48:51], v[64:67]
    ds_read_b128 v[32:35], v3 offset:448
    v_mfma_f32_16x16x32_bf16 v[64:67], a[156:159], v[52:55], v[64:67]
    ds_read_b128 v[36:39], v4 offset:448
    v_mfma_f32_16x16x32_bf16 v[64:67], a[180:183], v[56:59], v[64:67]
    ds_read_b128 v[40:43], v3 offset:512
    s_waitcnt lgkmcnt(4)
    v_mfma_f32_16x16x32_bf16 v[64:67], a[192:195], v[60:63], v[64:67]
    ds_read_b128 v[44:47], v4 offset:512
    v_mfma_f32_16x16x32_bf16 v[68:71], a[148:151], v[48:51], v[68:71]
    ds_read_b64_tr_b16 v[208:209], v14 offset:18432
    v_mfma_f32_16x16x32_bf16 v[68:71], a[160:163], v[52:55], v[68:71]
    ds_read_b64_tr_b16 v[210:211], v14 offset:19200
    v_mfma_f32_16x16x32_bf16 v[68:71], a[184:187], v[56:59], v[68:71]
    ds_read_b64_tr_b16 v[212:213], v17 offset:18464
    v_mfma_f32_16x16x32_bf16 v[68:71], a[196:199], v[60:63], v[68:71]
    ds_read_b64_tr_b16 v[214:215], v17 offset:19232
    v_mfma_f32_16x16x32_bf16 v[72:75], a[152:155], v[48:51], v[72:75]
    ds_read_b64_tr_b16 v[216:217], v14 offset:18496
    v_mfma_f32_16x16x32_bf16 v[72:75], a[164:167], v[52:55], v[72:75]
    ds_read_b64_tr_b16 v[218:219], v14 offset:19264
    v_mfma_f32_16x16x32_bf16 v[72:75], a[188:191], v[56:59], v[72:75]
    ds_read_b64_tr_b16 v[196:197], v13 offset:18432
    v_mfma_f32_16x16x32_bf16 v[72:75], a[200:203], v[60:63], v[72:75]
    ds_read_b64_tr_b16 v[198:199], v13 offset:19200
    v_mfma_f32_16x16x32_bf16 v[76:79], a[144:147], v[52:55], v[76:79]
    ds_read_b64_tr_b16 v[200:201], v16 offset:18464
    v_mfma_f32_16x16x32_bf16 v[76:79], a[180:183], v[60:63], v[76:79]
    ds_read_b64_tr_b16 v[202:203], v16 offset:19232
    v_mfma_f32_16x16x32_bf16 v[80:83], a[148:151], v[52:55], v[80:83]
    s_waitcnt lgkmcnt(7)
    ds_read_b64_tr_b16 v[204:205], v13 offset:18496
    v_mfma_f32_16x16x32_bf16 v[80:83], a[184:187], v[60:63], v[80:83]
    ds_read_b64_tr_b16 v[206:207], v13 offset:19264
    v_mfma_f32_16x16x32_bf16 v[84:87], a[152:155], v[52:55], v[84:87]
    ds_read_b64_tr_b16 v[184:185], v12 offset:18432
    v_mfma_f32_16x16x32_bf16 v[84:87], a[188:191], v[60:63], v[84:87]
    ds_read_b64_tr_b16 v[186:187], v12 offset:19200
    v_mfma_f32_16x16x32_bf16 v[64:67], a[216:219], v[32:35], v[64:67]
    ds_read_b64_tr_b16 v[188:189], v15 offset:18464
    v_mfma_f32_16x16x32_bf16 v[64:67], a[228:231], v[36:39], v[64:67]
    ds_read_b64_tr_b16 v[190:191], v15 offset:19232
    v_mfma_f32_16x16x32_bf16 v[68:71], a[220:223], v[32:35], v[68:71]
    ds_read_b64_tr_b16 v[192:193], v12 offset:18496
    v_mfma_f32_16x16x32_bf16 v[68:71], a[232:235], v[36:39], v[68:71]
    ds_read_b64_tr_b16 v[194:195], v12 offset:19264
    v_mfma_f32_16x16x32_bf16 v[72:75], a[224:227], v[32:35], v[72:75]
    v_mfma_f32_16x16x32_bf16 v[72:75], a[236:239], v[36:39], v[72:75]
    v_mfma_f32_16x16x32_bf16 v[76:79], a[216:219], v[36:39], v[76:79]
    v_mfma_f32_16x16x32_bf16 v[80:83], a[220:223], v[36:39], v[80:83]
    v_mfma_f32_16x16x32_bf16 v[84:87], a[224:227], v[36:39], v[84:87]
    s_waitcnt lgkmcnt(4)
    v_mfma_f32_16x16x32_bf16 v[64:67], v[184:187], v[40:43], v[64:67]
    ds_read_b128 v[148:151], v5 offset:288
    v_mfma_f32_16x16x32_bf16 v[64:67], v[196:199], v[44:47], v[64:67]
    s_waitcnt lgkmcnt(3)
    v_mfma_f32_16x16x32_bf16 v[68:71], v[188:191], v[40:43], v[68:71]
    ds_read_b128 v[152:155], v5 offset:352
    v_mfma_f32_16x16x32_bf16 v[68:71], v[200:203], v[44:47], v[68:71]
    s_waitcnt lgkmcnt(2)
    v_mfma_f32_16x16x32_bf16 v[72:75], v[192:195], v[40:43], v[72:75]
    ds_read_b128 v[156:159], v5 offset:448
    v_mfma_f32_16x16x32_bf16 v[72:75], v[204:207], v[44:47], v[72:75]
    v_mfma_f32_16x16x32_bf16 v[76:79], v[184:187], v[44:47], v[76:79]
    ds_read_b128 v[160:163], v5 offset:512
    v_mfma_f32_16x16x32_bf16 v[80:83], v[188:191], v[44:47], v[80:83]
    v_mfma_f32_16x16x32_bf16 v[84:87], v[192:195], v[44:47], v[84:87]
    s_waitcnt vmcnt(0)
    s_barrier
    s_waitcnt lgkmcnt(3)
    v_mfma_f32_16x16x32_bf16 v[64:67], a[168:171], v[148:151], v[64:67]
    ds_read_b64_tr_b16 v[244:245], v14 offset:55296
    s_waitcnt lgkmcnt(3)
    v_mfma_f32_16x16x32_bf16 v[64:67], a[204:207], v[152:155], v[64:67]
    ds_read_b64_tr_b16 v[246:247], v14 offset:56064
    s_waitcnt lgkmcnt(3)
    v_mfma_f32_16x16x32_bf16 v[64:67], a[240:243], v[156:159], v[64:67]
    ds_read_b64_tr_b16 v[248:249], v17 offset:55328
    s_waitcnt lgkmcnt(3)
    v_mfma_f32_16x16x32_bf16 v[64:67], v[208:211], v[160:163], v[64:67]
    v_mfma_f32_16x16x32_bf16 v[68:71], a[172:175], v[148:151], v[68:71]
    ds_read_b64_tr_b16 v[250:251], v17 offset:56096
    v_mfma_f32_16x16x32_bf16 v[68:71], a[208:211], v[152:155], v[68:71]
    ds_read_b64_tr_b16 v[252:253], v14 offset:55360
    v_mfma_f32_16x16x32_bf16 v[68:71], a[244:247], v[156:159], v[68:71]
    ds_read_b64_tr_b16 v[254:255], v14 offset:56128
    v_mfma_f32_16x16x32_bf16 v[68:71], v[212:215], v[160:163], v[68:71]
    v_mfma_f32_16x16x32_bf16 v[72:75], a[176:179], v[148:151], v[72:75]
    ds_read_b64_tr_b16 v[232:233], v13 offset:55296
    v_mfma_f32_16x16x32_bf16 v[72:75], a[212:215], v[152:155], v[72:75]
    ds_read_b64_tr_b16 v[234:235], v13 offset:56064
    v_mfma_f32_16x16x32_bf16 v[72:75], a[248:251], v[156:159], v[72:75]
    ds_read_b64_tr_b16 v[236:237], v16 offset:55328
    v_mfma_f32_16x16x32_bf16 v[72:75], v[216:219], v[160:163], v[72:75]
    v_mfma_f32_16x16x32_bf16 v[76:79], a[156:159], v[148:151], v[76:79]
    ds_read_b64_tr_b16 v[238:239], v16 offset:56096
    v_mfma_f32_16x16x32_bf16 v[76:79], a[192:195], v[152:155], v[76:79]
    ds_read_b64_tr_b16 v[240:241], v13 offset:55360
    v_mfma_f32_16x16x32_bf16 v[76:79], a[228:231], v[156:159], v[76:79]
    ds_read_b64_tr_b16 v[242:243], v13 offset:56128
    v_mfma_f32_16x16x32_bf16 v[76:79], v[196:199], v[160:163], v[76:79]
    v_mfma_f32_16x16x32_bf16 v[80:83], a[160:163], v[148:151], v[80:83]
    ds_read_b64_tr_b16 v[220:221], v12 offset:55296
    v_mfma_f32_16x16x32_bf16 v[80:83], a[196:199], v[152:155], v[80:83]
    ds_read_b64_tr_b16 v[222:223], v12 offset:56064
    v_mfma_f32_16x16x32_bf16 v[80:83], a[232:235], v[156:159], v[80:83]
    ds_read_b64_tr_b16 v[224:225], v15 offset:55328
    v_mfma_f32_16x16x32_bf16 v[80:83], v[200:203], v[160:163], v[80:83]
    v_mfma_f32_16x16x32_bf16 v[84:87], a[164:167], v[148:151], v[84:87]
    s_waitcnt lgkmcnt(7)
    ds_read_b64_tr_b16 v[226:227], v15 offset:56096
    v_mfma_f32_16x16x32_bf16 v[84:87], a[200:203], v[152:155], v[84:87]
    ds_read_b64_tr_b16 v[228:229], v12 offset:55360
    v_mfma_f32_16x16x32_bf16 v[84:87], a[236:239], v[156:159], v[84:87]
    ds_read_b64_tr_b16 v[230:231], v12 offset:56128
    v_mfma_f32_16x16x32_bf16 v[84:87], v[204:207], v[160:163], v[84:87]
    v_mfma_f32_16x16x32_bf16 v[88:91], a[144:147], v[148:151], v[88:91]
    ds_read_b128 v[164:167], v3 offset:576
    v_mfma_f32_16x16x32_bf16 v[88:91], a[180:183], v[152:155], v[88:91]
    ds_read_b128 v[168:171], v4 offset:576
    v_mfma_f32_16x16x32_bf16 v[88:91], a[216:219], v[156:159], v[88:91]
    ds_read_b128 v[60:63], v5 offset:576
    v_mfma_f32_16x16x32_bf16 v[88:91], v[184:187], v[160:163], v[88:91]
    v_mfma_f32_16x16x32_bf16 v[92:95], a[148:151], v[148:151], v[92:95]
    v_mfma_f32_16x16x32_bf16 v[92:95], a[184:187], v[152:155], v[92:95]
    v_mfma_f32_16x16x32_bf16 v[92:95], a[220:223], v[156:159], v[92:95]
    v_mfma_f32_16x16x32_bf16 v[92:95], v[188:191], v[160:163], v[92:95]
    v_mfma_f32_16x16x32_bf16 v[96:99], a[152:155], v[148:151], v[96:99]
    v_mfma_f32_16x16x32_bf16 v[96:99], a[188:191], v[152:155], v[96:99]
    v_mfma_f32_16x16x32_bf16 v[96:99], a[224:227], v[156:159], v[96:99]
    v_mfma_f32_16x16x32_bf16 v[96:99], v[192:195], v[160:163], v[96:99]
    s_waitcnt lgkmcnt(2)
    v_mfma_f32_16x16x32_bf16 v[64:67], v[220:223], v[164:167], v[64:67]
    ds_read_b128 v[32:35], v6 offset:288
    s_waitcnt lgkmcnt(2)
    v_mfma_f32_16x16x32_bf16 v[64:67], v[232:235], v[168:171], v[64:67]
    ds_read_b128 v[36:39], v6 offset:352
    s_waitcnt lgkmcnt(2)
    v_mfma_f32_16x16x32_bf16 v[64:67], v[244:247], v[60:63], v[64:67]
    ds_read_b128 v[40:43], v6 offset:448
    v_mfma_f32_16x16x32_bf16 v[68:71], v[224:227], v[164:167], v[68:71]
    v_mfma_f32_16x16x32_bf16 v[68:71], v[236:239], v[168:171], v[68:71]
    ds_read_b128 v[44:47], v6 offset:512
    v_mfma_f32_16x16x32_bf16 v[68:71], v[248:251], v[60:63], v[68:71]
    ds_read_b128 v[48:51], v6 offset:576
    v_mfma_f32_16x16x32_bf16 v[72:75], v[228:231], v[164:167], v[72:75]
    v_mfma_f32_16x16x32_bf16 v[72:75], v[240:243], v[168:171], v[72:75]
    v_mfma_f32_16x16x32_bf16 v[72:75], v[252:255], v[60:63], v[72:75]
    v_mfma_f32_16x16x32_bf16 v[76:79], v[220:223], v[168:171], v[76:79]
    v_mfma_f32_16x16x32_bf16 v[76:79], v[232:235], v[60:63], v[76:79]
    v_mfma_f32_16x16x32_bf16 v[80:83], v[224:227], v[168:171], v[80:83]
    v_mfma_f32_16x16x32_bf16 v[80:83], v[236:239], v[60:63], v[80:83]
    v_mfma_f32_16x16x32_bf16 v[84:87], v[228:231], v[168:171], v[84:87]
    v_mfma_f32_16x16x32_bf16 v[84:87], v[240:243], v[60:63], v[84:87]
    v_mfma_f32_16x16x32_bf16 v[88:91], v[220:223], v[60:63], v[88:91]
    v_mfma_f32_16x16x32_bf16 v[92:95], v[224:227], v[60:63], v[92:95]
    v_mfma_f32_16x16x32_bf16 v[96:99], v[228:231], v[60:63], v[96:99]
    s_waitcnt lgkmcnt(4)
    v_mfma_f32_16x16x32_bf16 v[76:79], a[168:171], v[32:35], v[76:79]
    v_cvt_pk_bf16_f32 v64, v64, v65
    s_waitcnt lgkmcnt(3)
    v_mfma_f32_16x16x32_bf16 v[76:79], a[204:207], v[36:39], v[76:79]
    v_cvt_pk_bf16_f32 v65, v66, v67
    s_waitcnt lgkmcnt(2)
    v_mfma_f32_16x16x32_bf16 v[76:79], a[240:243], v[40:43], v[76:79]
    s_waitcnt lgkmcnt(1)
    v_mfma_f32_16x16x32_bf16 v[76:79], v[208:211], v[44:47], v[76:79]
    v_cvt_pk_bf16_f32 v66, v68, v69
    s_waitcnt lgkmcnt(0)
    v_mfma_f32_16x16x32_bf16 v[76:79], v[244:247], v[48:51], v[76:79]
    v_cvt_pk_bf16_f32 v67, v70, v71
    v_mfma_f32_16x16x32_bf16 v[80:83], a[172:175], v[32:35], v[80:83]
    v_mfma_f32_16x16x32_bf16 v[80:83], a[208:211], v[36:39], v[80:83]
    v_cvt_pk_bf16_f32 v72, v72, v73
    v_mfma_f32_16x16x32_bf16 v[80:83], a[244:247], v[40:43], v[80:83]
    v_cvt_pk_bf16_f32 v73, v74, v75
    v_mfma_f32_16x16x32_bf16 v[80:83], v[212:215], v[44:47], v[80:83]
    v_mfma_f32_16x16x32_bf16 v[80:83], v[248:251], v[48:51], v[80:83]
    v_permlane16_swap_b32 v64, v66
    v_mfma_f32_16x16x32_bf16 v[84:87], a[176:179], v[32:35], v[84:87]
    v_permlane16_swap_b32 v65, v67
    v_mfma_f32_16x16x32_bf16 v[84:87], a[212:215], v[36:39], v[84:87]
    v_mfma_f32_16x16x32_bf16 v[84:87], a[248:251], v[40:43], v[84:87]
    ds_write_b64 v20, v[72:73] offset:64
    v_mfma_f32_16x16x32_bf16 v[84:87], v[216:219], v[44:47], v[84:87]
    ds_write_b128 v0, v[64:67] offset:0
    v_mfma_f32_16x16x32_bf16 v[84:87], v[252:255], v[48:51], v[84:87]
    v_mfma_f32_16x16x32_bf16 v[88:91], a[156:159], v[32:35], v[88:91]
    v_cvt_pk_bf16_f32 v76, v76, v77
    v_mfma_f32_16x16x32_bf16 v[88:91], a[192:195], v[36:39], v[88:91]
    v_cvt_pk_bf16_f32 v77, v78, v79
    v_mfma_f32_16x16x32_bf16 v[88:91], a[228:231], v[40:43], v[88:91]
    v_cvt_pk_bf16_f32 v78, v80, v81
    v_mfma_f32_16x16x32_bf16 v[88:91], v[196:199], v[44:47], v[88:91]
    v_cvt_pk_bf16_f32 v79, v82, v83
    v_mfma_f32_16x16x32_bf16 v[88:91], v[232:235], v[48:51], v[88:91]
    v_cvt_pk_bf16_f32 v84, v84, v85
    v_mfma_f32_16x16x32_bf16 v[92:95], a[160:163], v[32:35], v[92:95]
    v_cvt_pk_bf16_f32 v85, v86, v87
    v_mfma_f32_16x16x32_bf16 v[92:95], a[196:199], v[36:39], v[92:95]
    v_permlane16_swap_b32 v76, v78
    v_mfma_f32_16x16x32_bf16 v[92:95], a[232:235], v[40:43], v[92:95]
    v_permlane16_swap_b32 v77, v79
    v_mfma_f32_16x16x32_bf16 v[92:95], v[200:203], v[44:47], v[92:95]
    ds_write_b64 v20, v[84:85] offset:3392
    v_mfma_f32_16x16x32_bf16 v[92:95], v[236:239], v[48:51], v[92:95]
    ds_write_b128 v0, v[76:79] offset:3328
    v_mfma_f32_16x16x32_bf16 v[96:99], a[164:167], v[32:35], v[96:99]
    v_mfma_f32_16x16x32_bf16 v[96:99], a[200:203], v[36:39], v[96:99]
    v_mfma_f32_16x16x32_bf16 v[96:99], a[236:239], v[40:43], v[96:99]
    v_mfma_f32_16x16x32_bf16 v[96:99], v[204:207], v[44:47], v[96:99]
    v_mfma_f32_16x16x32_bf16 v[96:99], v[240:243], v[48:51], v[96:99]
    s_waitcnt lgkmcnt(0)
    s_barrier
    v_mfma_f32_16x16x32_bf16 v[100:103], a[144:147], v[32:35], v[100:103]
    ds_read_b128 v[148:151], v7 offset:288
    v_mfma_f32_16x16x32_bf16 v[100:103], a[180:183], v[36:39], v[100:103]
    ds_read_b128 v[152:155], v7 offset:352
    v_mfma_f32_16x16x32_bf16 v[100:103], a[216:219], v[40:43], v[100:103]
    ds_read_b128 v[156:159], v7 offset:448
    v_mfma_f32_16x16x32_bf16 v[100:103], v[184:187], v[44:47], v[100:103]
    ds_read_b128 v[160:163], v7 offset:512
    v_mfma_f32_16x16x32_bf16 v[100:103], v[220:223], v[48:51], v[100:103]
    v_mfma_f32_16x16x32_bf16 v[104:107], a[148:151], v[32:35], v[104:107]
    ds_read_b128 v[164:167], v7 offset:576
    v_mfma_f32_16x16x32_bf16 v[104:107], a[184:187], v[36:39], v[104:107]
    ds_read_b128 v[64:67], v180 offset:0
    v_mfma_f32_16x16x32_bf16 v[104:107], a[220:223], v[40:43], v[104:107]
    ds_read_b128 v[68:71], v181 offset:0
    v_mfma_f32_16x16x32_bf16 v[104:107], v[188:191], v[44:47], v[104:107]
    s_mul_i32 s50, s58, 0
    s_add_u32 s50, s50, s57
    v_mfma_f32_16x16x32_bf16 v[104:107], v[224:227], v[48:51], v[104:107]
    v_mfma_f32_16x16x32_bf16 v[108:111], a[152:155], v[32:35], v[108:111]
    ds_read_b128 v[76:79], v180 offset:3328
    v_mfma_f32_16x16x32_bf16 v[108:111], a[188:191], v[36:39], v[108:111]
    ds_read_b128 v[80:83], v181 offset:3328
    v_mfma_f32_16x16x32_bf16 v[108:111], a[224:227], v[40:43], v[108:111]
    s_waitcnt lgkmcnt(3)
    buffer_store_dwordx4 v[64:67], v182, s[36:39], s50 offen sc1
    v_mfma_f32_16x16x32_bf16 v[108:111], v[192:195], v[44:47], v[108:111]
    s_waitcnt lgkmcnt(2)
    buffer_store_dwordx4 v[68:71], v183, s[36:39], s50 offen sc1
    v_mfma_f32_16x16x32_bf16 v[108:111], v[228:231], v[48:51], v[108:111]
    v_mfma_f32_16x16x32_bf16 v[88:91], a[168:171], v[148:151], v[88:91]
    s_mul_i32 s50, s58, 1
    s_add_u32 s50, s50, s57
    v_mfma_f32_16x16x32_bf16 v[88:91], a[204:207], v[152:155], v[88:91]
    s_waitcnt lgkmcnt(1)
    buffer_store_dwordx4 v[76:79], v182, s[36:39], s50 offen sc1
    v_mfma_f32_16x16x32_bf16 v[88:91], a[240:243], v[156:159], v[88:91]
    v_mfma_f32_16x16x32_bf16 v[88:91], v[208:211], v[160:163], v[88:91]
    s_waitcnt lgkmcnt(0)
    buffer_store_dwordx4 v[80:83], v183, s[36:39], s50 offen sc1
    v_mfma_f32_16x16x32_bf16 v[88:91], v[244:247], v[164:167], v[88:91]
    v_mfma_f32_16x16x32_bf16 v[92:95], a[172:175], v[148:151], v[92:95]
    ds_read_b128 v[32:35], v8 offset:288
    v_mfma_f32_16x16x32_bf16 v[92:95], a[208:211], v[152:155], v[92:95]
    v_mfma_f32_16x16x32_bf16 v[92:95], a[244:247], v[156:159], v[92:95]
    ds_read_b128 v[36:39], v8 offset:352
    v_mfma_f32_16x16x32_bf16 v[92:95], v[212:215], v[160:163], v[92:95]
    v_mfma_f32_16x16x32_bf16 v[92:95], v[248:251], v[164:167], v[92:95]
    ds_read_b128 v[40:43], v8 offset:448
    v_mfma_f32_16x16x32_bf16 v[96:99], a[176:179], v[148:151], v[96:99]
    v_mfma_f32_16x16x32_bf16 v[96:99], a[212:215], v[152:155], v[96:99]
    ds_read_b128 v[44:47], v8 offset:512
    v_mfma_f32_16x16x32_bf16 v[96:99], a[248:251], v[156:159], v[96:99]
    v_mfma_f32_16x16x32_bf16 v[96:99], v[216:219], v[160:163], v[96:99]
    ds_read_b128 v[48:51], v8 offset:576
    v_mfma_f32_16x16x32_bf16 v[96:99], v[252:255], v[164:167], v[96:99]
    v_mfma_f32_16x16x32_bf16 v[100:103], a[156:159], v[148:151], v[100:103]
    v_cvt_pk_bf16_f32 v88, v88, v89
    v_mfma_f32_16x16x32_bf16 v[100:103], a[192:195], v[152:155], v[100:103]
    v_cvt_pk_bf16_f32 v89, v90, v91
    v_mfma_f32_16x16x32_bf16 v[100:103], a[228:231], v[156:159], v[100:103]
    v_cvt_pk_bf16_f32 v90, v92, v93
    v_mfma_f32_16x16x32_bf16 v[100:103], v[196:199], v[160:163], v[100:103]
    v_cvt_pk_bf16_f32 v91, v94, v95
    v_mfma_f32_16x16x32_bf16 v[100:103], v[232:235], v[164:167], v[100:103]
    v_cvt_pk_bf16_f32 v96, v96, v97
    v_mfma_f32_16x16x32_bf16 v[104:107], a[160:163], v[148:151], v[104:107]
    v_cvt_pk_bf16_f32 v97, v98, v99
    v_mfma_f32_16x16x32_bf16 v[104:107], a[196:199], v[152:155], v[104:107]
    v_permlane16_swap_b32 v88, v90
    v_mfma_f32_16x16x32_bf16 v[104:107], a[232:235], v[156:159], v[104:107]
    v_permlane16_swap_b32 v89, v91
    v_mfma_f32_16x16x32_bf16 v[104:107], v[200:203], v[160:163], v[104:107]
    ds_write_b64 v20, v[96:97] offset:6720
    v_mfma_f32_16x16x32_bf16 v[104:107], v[236:239], v[164:167], v[104:107]
    ds_write_b128 v0, v[88:91] offset:6656
    v_mfma_f32_16x16x32_bf16 v[108:111], a[164:167], v[148:151], v[108:111]
    v_mfma_f32_16x16x32_bf16 v[108:111], a[200:203], v[152:155], v[108:111]
    v_mfma_f32_16x16x32_bf16 v[108:111], a[236:239], v[156:159], v[108:111]
    v_mfma_f32_16x16x32_bf16 v[108:111], v[204:207], v[160:163], v[108:111]
    v_mfma_f32_16x16x32_bf16 v[108:111], v[240:243], v[164:167], v[108:111]
    s_waitcnt lgkmcnt(0)
    s_barrier
    v_mfma_f32_16x16x32_bf16 v[112:115], a[144:147], v[148:151], v[112:115]
    ds_read_b128 v[88:91], v180 offset:6656
    v_mfma_f32_16x16x32_bf16 v[112:115], a[180:183], v[152:155], v[112:115]
    ds_read_b128 v[92:95], v181 offset:6656
    v_mfma_f32_16x16x32_bf16 v[112:115], a[216:219], v[156:159], v[112:115]
    v_mfma_f32_16x16x32_bf16 v[112:115], v[184:187], v[160:163], v[112:115]
    s_mul_i32 s50, s58, 2
    s_add_u32 s50, s50, s57
    v_mfma_f32_16x16x32_bf16 v[112:115], v[220:223], v[164:167], v[112:115]
    v_mfma_f32_16x16x32_bf16 v[116:119], a[148:151], v[148:151], v[116:119]
    v_mfma_f32_16x16x32_bf16 v[116:119], a[184:187], v[152:155], v[116:119]
    v_mfma_f32_16x16x32_bf16 v[116:119], a[220:223], v[156:159], v[116:119]
    v_mfma_f32_16x16x32_bf16 v[116:119], v[188:191], v[160:163], v[116:119]
    v_mfma_f32_16x16x32_bf16 v[116:119], v[224:227], v[164:167], v[116:119]
    v_mfma_f32_16x16x32_bf16 v[120:123], a[152:155], v[148:151], v[120:123]
    s_waitcnt lgkmcnt(1)
    buffer_store_dwordx4 v[88:91], v182, s[36:39], s50 offen sc1
    v_mfma_f32_16x16x32_bf16 v[120:123], a[188:191], v[152:155], v[120:123]
    v_mfma_f32_16x16x32_bf16 v[120:123], a[224:227], v[156:159], v[120:123]
    v_mfma_f32_16x16x32_bf16 v[120:123], v[192:195], v[160:163], v[120:123]
    s_waitcnt lgkmcnt(0)
    buffer_store_dwordx4 v[92:95], v183, s[36:39], s50 offen sc1
    v_mfma_f32_16x16x32_bf16 v[120:123], v[228:231], v[164:167], v[120:123]
    v_mfma_f32_16x16x32_bf16 v[100:103], a[168:171], v[32:35], v[100:103]
    ds_read_b128 v[148:151], v9 offset:288
    v_mfma_f32_16x16x32_bf16 v[100:103], a[204:207], v[36:39], v[100:103]
    v_mfma_f32_16x16x32_bf16 v[100:103], a[240:243], v[40:43], v[100:103]
    v_mfma_f32_16x16x32_bf16 v[100:103], v[208:211], v[44:47], v[100:103]
    ds_read_b128 v[152:155], v9 offset:352
    v_mfma_f32_16x16x32_bf16 v[100:103], v[244:247], v[48:51], v[100:103]
    v_mfma_f32_16x16x32_bf16 v[104:107], a[172:175], v[32:35], v[104:107]
    v_mfma_f32_16x16x32_bf16 v[104:107], a[208:211], v[36:39], v[104:107]
    ds_read_b128 v[156:159], v9 offset:448
    v_mfma_f32_16x16x32_bf16 v[104:107], a[244:247], v[40:43], v[104:107]
    v_mfma_f32_16x16x32_bf16 v[104:107], v[212:215], v[44:47], v[104:107]
    v_mfma_f32_16x16x32_bf16 v[104:107], v[248:251], v[48:51], v[104:107]
    ds_read_b128 v[160:163], v9 offset:512
    v_mfma_f32_16x16x32_bf16 v[108:111], a[176:179], v[32:35], v[108:111]
    v_mfma_f32_16x16x32_bf16 v[108:111], a[212:215], v[36:39], v[108:111]
    v_mfma_f32_16x16x32_bf16 v[108:111], a[248:251], v[40:43], v[108:111]
    ds_read_b128 v[164:167], v9 offset:576
    v_mfma_f32_16x16x32_bf16 v[108:111], v[216:219], v[44:47], v[108:111]
    v_mfma_f32_16x16x32_bf16 v[108:111], v[252:255], v[48:51], v[108:111]
    v_mfma_f32_16x16x32_bf16 v[112:115], a[156:159], v[32:35], v[112:115]
    v_cvt_pk_bf16_f32 v100, v100, v101
    v_mfma_f32_16x16x32_bf16 v[112:115], a[192:195], v[36:39], v[112:115]
    v_cvt_pk_bf16_f32 v101, v102, v103
    v_mfma_f32_16x16x32_bf16 v[112:115], a[228:231], v[40:43], v[112:115]
    v_cvt_pk_bf16_f32 v102, v104, v105
    v_mfma_f32_16x16x32_bf16 v[112:115], v[196:199], v[44:47], v[112:115]
    v_cvt_pk_bf16_f32 v103, v106, v107
    v_mfma_f32_16x16x32_bf16 v[112:115], v[232:235], v[48:51], v[112:115]
    v_cvt_pk_bf16_f32 v108, v108, v109
    v_mfma_f32_16x16x32_bf16 v[116:119], a[160:163], v[32:35], v[116:119]
    v_cvt_pk_bf16_f32 v109, v110, v111
    v_mfma_f32_16x16x32_bf16 v[116:119], a[196:199], v[36:39], v[116:119]
    v_permlane16_swap_b32 v100, v102
    v_mfma_f32_16x16x32_bf16 v[116:119], a[232:235], v[40:43], v[116:119]
    v_permlane16_swap_b32 v101, v103
    v_mfma_f32_16x16x32_bf16 v[116:119], v[200:203], v[44:47], v[116:119]
    ds_write_b64 v20, v[108:109] offset:10048
    v_mfma_f32_16x16x32_bf16 v[116:119], v[236:239], v[48:51], v[116:119]
    ds_write_b128 v0, v[100:103] offset:9984
    v_mfma_f32_16x16x32_bf16 v[120:123], a[164:167], v[32:35], v[120:123]
    v_mfma_f32_16x16x32_bf16 v[120:123], a[200:203], v[36:39], v[120:123]
    v_mfma_f32_16x16x32_bf16 v[120:123], a[236:239], v[40:43], v[120:123]
    v_mfma_f32_16x16x32_bf16 v[120:123], v[204:207], v[44:47], v[120:123]
    v_mfma_f32_16x16x32_bf16 v[120:123], v[240:243], v[48:51], v[120:123]
    s_waitcnt lgkmcnt(0)
    s_barrier
    v_mfma_f32_16x16x32_bf16 v[124:127], a[144:147], v[32:35], v[124:127]
    ds_read_b128 v[100:103], v180 offset:9984
    v_mfma_f32_16x16x32_bf16 v[124:127], a[180:183], v[36:39], v[124:127]
    ds_read_b128 v[104:107], v181 offset:9984
    v_mfma_f32_16x16x32_bf16 v[124:127], a[216:219], v[40:43], v[124:127]
    v_mfma_f32_16x16x32_bf16 v[124:127], v[184:187], v[44:47], v[124:127]
    s_mul_i32 s50, s58, 3
    s_add_u32 s50, s50, s57
    v_mfma_f32_16x16x32_bf16 v[124:127], v[220:223], v[48:51], v[124:127]
    v_mfma_f32_16x16x32_bf16 v[128:131], a[148:151], v[32:35], v[128:131]
    v_mfma_f32_16x16x32_bf16 v[128:131], a[184:187], v[36:39], v[128:131]
    v_mfma_f32_16x16x32_bf16 v[128:131], a[220:223], v[40:43], v[128:131]
    v_mfma_f32_16x16x32_bf16 v[128:131], v[188:191], v[44:47], v[128:131]
    v_mfma_f32_16x16x32_bf16 v[128:131], v[224:227], v[48:51], v[128:131]
    v_mfma_f32_16x16x32_bf16 v[132:135], a[152:155], v[32:35], v[132:135]
    s_waitcnt lgkmcnt(1)
    buffer_store_dwordx4 v[100:103], v182, s[36:39], s50 offen sc1
    v_mfma_f32_16x16x32_bf16 v[132:135], a[188:191], v[36:39], v[132:135]
    v_mfma_f32_16x16x32_bf16 v[132:135], a[224:227], v[40:43], v[132:135]
    v_mfma_f32_16x16x32_bf16 v[132:135], v[192:195], v[44:47], v[132:135]
    s_waitcnt lgkmcnt(0)
    buffer_store_dwordx4 v[104:107], v183, s[36:39], s50 offen sc1
    v_mfma_f32_16x16x32_bf16 v[132:135], v[228:231], v[48:51], v[132:135]
    v_mfma_f32_16x16x32_bf16 v[112:115], a[168:171], v[148:151], v[112:115]
    ds_read_b128 v[32:35], v10 offset:288
    v_mfma_f32_16x16x32_bf16 v[112:115], a[204:207], v[152:155], v[112:115]
    v_mfma_f32_16x16x32_bf16 v[112:115], a[240:243], v[156:159], v[112:115]
    v_mfma_f32_16x16x32_bf16 v[112:115], v[208:211], v[160:163], v[112:115]
    ds_read_b128 v[36:39], v10 offset:352
    v_mfma_f32_16x16x32_bf16 v[112:115], v[244:247], v[164:167], v[112:115]
    v_mfma_f32_16x16x32_bf16 v[116:119], a[172:175], v[148:151], v[116:119]
    v_mfma_f32_16x16x32_bf16 v[116:119], a[208:211], v[152:155], v[116:119]
    ds_read_b128 v[40:43], v10 offset:448
    v_mfma_f32_16x16x32_bf16 v[116:119], a[244:247], v[156:159], v[116:119]
    v_mfma_f32_16x16x32_bf16 v[116:119], v[212:215], v[160:163], v[116:119]
    v_mfma_f32_16x16x32_bf16 v[116:119], v[248:251], v[164:167], v[116:119]
    ds_read_b128 v[44:47], v10 offset:512
    v_mfma_f32_16x16x32_bf16 v[120:123], a[176:179], v[148:151], v[120:123]
    v_mfma_f32_16x16x32_bf16 v[120:123], a[212:215], v[152:155], v[120:123]
    v_mfma_f32_16x16x32_bf16 v[120:123], a[248:251], v[156:159], v[120:123]
    ds_read_b128 v[48:51], v10 offset:576
    v_mfma_f32_16x16x32_bf16 v[120:123], v[216:219], v[160:163], v[120:123]
    v_mfma_f32_16x16x32_bf16 v[120:123], v[252:255], v[164:167], v[120:123]
    v_mfma_f32_16x16x32_bf16 v[124:127], a[156:159], v[148:151], v[124:127]
    v_cvt_pk_bf16_f32 v112, v112, v113
    v_mfma_f32_16x16x32_bf16 v[124:127], a[192:195], v[152:155], v[124:127]
    v_cvt_pk_bf16_f32 v113, v114, v115
    v_mfma_f32_16x16x32_bf16 v[124:127], a[228:231], v[156:159], v[124:127]
    v_cvt_pk_bf16_f32 v114, v116, v117
    v_mfma_f32_16x16x32_bf16 v[124:127], v[196:199], v[160:163], v[124:127]
    v_cvt_pk_bf16_f32 v115, v118, v119
    v_mfma_f32_16x16x32_bf16 v[124:127], v[232:235], v[164:167], v[124:127]
    v_cvt_pk_bf16_f32 v120, v120, v121
    v_mfma_f32_16x16x32_bf16 v[128:131], a[160:163], v[148:151], v[128:131]
    v_cvt_pk_bf16_f32 v121, v122, v123
    v_mfma_f32_16x16x32_bf16 v[128:131], a[196:199], v[152:155], v[128:131]
    v_permlane16_swap_b32 v112, v114
    v_mfma_f32_16x16x32_bf16 v[128:131], a[232:235], v[156:159], v[128:131]
    v_permlane16_swap_b32 v113, v115
    v_mfma_f32_16x16x32_bf16 v[128:131], v[200:203], v[160:163], v[128:131]
    ds_write_b64 v20, v[120:121] offset:13376
    v_mfma_f32_16x16x32_bf16 v[128:131], v[236:239], v[164:167], v[128:131]
    ds_write_b128 v0, v[112:115] offset:13312
    v_mfma_f32_16x16x32_bf16 v[132:135], a[164:167], v[148:151], v[132:135]
    v_mfma_f32_16x16x32_bf16 v[132:135], a[200:203], v[152:155], v[132:135]
    v_mfma_f32_16x16x32_bf16 v[132:135], a[236:239], v[156:159], v[132:135]
    v_mfma_f32_16x16x32_bf16 v[132:135], v[204:207], v[160:163], v[132:135]
    v_mfma_f32_16x16x32_bf16 v[132:135], v[240:243], v[164:167], v[132:135]
    s_waitcnt lgkmcnt(0)
    s_barrier
    v_mfma_f32_16x16x32_bf16 v[136:139], a[144:147], v[148:151], v[136:139]
    ds_read_b128 v[112:115], v180 offset:13312
    v_mfma_f32_16x16x32_bf16 v[136:139], a[180:183], v[152:155], v[136:139]
    ds_read_b128 v[116:119], v181 offset:13312
    v_mfma_f32_16x16x32_bf16 v[136:139], a[216:219], v[156:159], v[136:139]
    v_mfma_f32_16x16x32_bf16 v[136:139], v[184:187], v[160:163], v[136:139]
    s_mul_i32 s50, s58, 4
    s_add_u32 s50, s50, s57
    v_mfma_f32_16x16x32_bf16 v[136:139], v[220:223], v[164:167], v[136:139]
    v_mfma_f32_16x16x32_bf16 v[140:143], a[148:151], v[148:151], v[140:143]
    v_mfma_f32_16x16x32_bf16 v[140:143], a[184:187], v[152:155], v[140:143]
    v_mfma_f32_16x16x32_bf16 v[140:143], a[220:223], v[156:159], v[140:143]
    v_mfma_f32_16x16x32_bf16 v[140:143], v[188:191], v[160:163], v[140:143]
    v_mfma_f32_16x16x32_bf16 v[140:143], v[224:227], v[164:167], v[140:143]
    v_mfma_f32_16x16x32_bf16 v[144:147], a[152:155], v[148:151], v[144:147]
    s_waitcnt lgkmcnt(1)
    buffer_store_dwordx4 v[112:115], v182, s[36:39], s50 offen sc1
    v_mfma_f32_16x16x32_bf16 v[144:147], a[188:191], v[152:155], v[144:147]
    v_mfma_f32_16x16x32_bf16 v[144:147], a[224:227], v[156:159], v[144:147]
    v_mfma_f32_16x16x32_bf16 v[144:147], v[192:195], v[160:163], v[144:147]
    s_waitcnt lgkmcnt(0)
    buffer_store_dwordx4 v[116:119], v183, s[36:39], s50 offen sc1
    v_mfma_f32_16x16x32_bf16 v[144:147], v[228:231], v[164:167], v[144:147]
    v_mfma_f32_16x16x32_bf16 v[124:127], a[168:171], v[32:35], v[124:127]
    ds_read_b128 v[148:151], v11 offset:288
    v_mfma_f32_16x16x32_bf16 v[124:127], a[204:207], v[36:39], v[124:127]
    v_mfma_f32_16x16x32_bf16 v[124:127], a[240:243], v[40:43], v[124:127]
    v_mfma_f32_16x16x32_bf16 v[124:127], v[208:211], v[44:47], v[124:127]
    ds_read_b128 v[152:155], v11 offset:352
    v_mfma_f32_16x16x32_bf16 v[124:127], v[244:247], v[48:51], v[124:127]
    v_mfma_f32_16x16x32_bf16 v[128:131], a[172:175], v[32:35], v[128:131]
    v_mfma_f32_16x16x32_bf16 v[128:131], a[208:211], v[36:39], v[128:131]
    ds_read_b128 v[156:159], v11 offset:448
    v_mfma_f32_16x16x32_bf16 v[128:131], a[244:247], v[40:43], v[128:131]
    v_mfma_f32_16x16x32_bf16 v[128:131], v[212:215], v[44:47], v[128:131]
    v_mfma_f32_16x16x32_bf16 v[128:131], v[248:251], v[48:51], v[128:131]
    ds_read_b128 v[160:163], v11 offset:512
    v_mfma_f32_16x16x32_bf16 v[132:135], a[176:179], v[32:35], v[132:135]
    v_mfma_f32_16x16x32_bf16 v[132:135], a[212:215], v[36:39], v[132:135]
    v_mfma_f32_16x16x32_bf16 v[132:135], a[248:251], v[40:43], v[132:135]
    ds_read_b128 v[164:167], v11 offset:576
    v_mfma_f32_16x16x32_bf16 v[132:135], v[216:219], v[44:47], v[132:135]
    v_mfma_f32_16x16x32_bf16 v[132:135], v[252:255], v[48:51], v[132:135]
    v_mfma_f32_16x16x32_bf16 v[136:139], a[156:159], v[32:35], v[136:139]
    v_cvt_pk_bf16_f32 v124, v124, v125
    v_mfma_f32_16x16x32_bf16 v[136:139], a[192:195], v[36:39], v[136:139]
    v_cvt_pk_bf16_f32 v125, v126, v127
    v_mfma_f32_16x16x32_bf16 v[136:139], a[228:231], v[40:43], v[136:139]
    v_cvt_pk_bf16_f32 v126, v128, v129
    v_mfma_f32_16x16x32_bf16 v[136:139], v[196:199], v[44:47], v[136:139]
    v_cvt_pk_bf16_f32 v127, v130, v131
    v_mfma_f32_16x16x32_bf16 v[136:139], v[232:235], v[48:51], v[136:139]
    v_cvt_pk_bf16_f32 v132, v132, v133
    v_mfma_f32_16x16x32_bf16 v[140:143], a[160:163], v[32:35], v[140:143]
    v_cvt_pk_bf16_f32 v133, v134, v135
    v_mfma_f32_16x16x32_bf16 v[140:143], a[196:199], v[36:39], v[140:143]
    v_permlane16_swap_b32 v124, v126
    v_mfma_f32_16x16x32_bf16 v[140:143], a[232:235], v[40:43], v[140:143]
    v_permlane16_swap_b32 v125, v127
    v_mfma_f32_16x16x32_bf16 v[140:143], v[200:203], v[44:47], v[140:143]
    ds_write_b64 v20, v[132:133] offset:16704
    v_mfma_f32_16x16x32_bf16 v[140:143], v[236:239], v[48:51], v[140:143]
    ds_write_b128 v0, v[124:127] offset:16640
    v_mfma_f32_16x16x32_bf16 v[144:147], a[164:167], v[32:35], v[144:147]
    v_mfma_f32_16x16x32_bf16 v[144:147], a[200:203], v[36:39], v[144:147]
    v_mfma_f32_16x16x32_bf16 v[144:147], a[236:239], v[40:43], v[144:147]
    v_mfma_f32_16x16x32_bf16 v[144:147], v[204:207], v[44:47], v[144:147]
    v_mfma_f32_16x16x32_bf16 v[144:147], v[240:243], v[48:51], v[144:147]
    s_waitcnt lgkmcnt(0)
    s_barrier
    v_mfma_f32_16x16x32_bf16 v[136:139], a[168:171], v[148:151], v[136:139]
    ds_read_b128 v[124:127], v180 offset:16640
    v_mfma_f32_16x16x32_bf16 v[136:139], a[204:207], v[152:155], v[136:139]
    ds_read_b128 v[128:131], v181 offset:16640
    v_mfma_f32_16x16x32_bf16 v[136:139], a[240:243], v[156:159], v[136:139]
    s_mul_i32 s50, s58, 5
    s_add_u32 s50, s50, s57
    v_mfma_f32_16x16x32_bf16 v[136:139], v[208:211], v[160:163], v[136:139]
    v_mfma_f32_16x16x32_bf16 v[136:139], v[244:247], v[164:167], v[136:139]
    v_mfma_f32_16x16x32_bf16 v[140:143], a[172:175], v[148:151], v[140:143]
    v_mfma_f32_16x16x32_bf16 v[140:143], a[208:211], v[152:155], v[140:143]
    v_mfma_f32_16x16x32_bf16 v[140:143], a[244:247], v[156:159], v[140:143]
    v_mfma_f32_16x16x32_bf16 v[140:143], v[212:215], v[160:163], v[140:143]
    s_waitcnt lgkmcnt(1)
    buffer_store_dwordx4 v[124:127], v182, s[36:39], s50 offen sc1
    v_mfma_f32_16x16x32_bf16 v[140:143], v[248:251], v[164:167], v[140:143]
    v_mfma_f32_16x16x32_bf16 v[144:147], a[176:179], v[148:151], v[144:147]
    s_waitcnt lgkmcnt(0)
    buffer_store_dwordx4 v[128:131], v183, s[36:39], s50 offen sc1
    v_mfma_f32_16x16x32_bf16 v[144:147], a[212:215], v[152:155], v[144:147]
    v_mfma_f32_16x16x32_bf16 v[144:147], a[248:251], v[156:159], v[144:147]
    v_cvt_pk_bf16_f32 v136, v136, v137
    v_mfma_f32_16x16x32_bf16 v[144:147], v[216:219], v[160:163], v[144:147]
    v_cvt_pk_bf16_f32 v137, v138, v139
    v_mfma_f32_16x16x32_bf16 v[144:147], v[252:255], v[164:167], v[144:147]
    v_cvt_pk_bf16_f32 v138, v140, v141
    v_cvt_pk_bf16_f32 v139, v142, v143
    s_nop 0
    v_permlane16_swap_b32 v136, v138
    v_permlane16_swap_b32 v137, v139
    ds_write_b128 v0, v[136:139] offset:19968
    s_nop 1
    v_cvt_pk_bf16_f32 v144, v144, v145
    v_cvt_pk_bf16_f32 v145, v146, v147
    ds_write_b64 v20, v[144:145] offset:20032
    s_waitcnt lgkmcnt(0)
    s_barrier
    ds_read_b128 v[136:139], v180 offset:19968
    ds_read_b128 v[140:143], v181 offset:19968
    s_mul_i32 s50, s58, 6
    s_add_u32 s50, s50, s57
    s_waitcnt lgkmcnt(1)
    buffer_store_dwordx4 v[136:139], v182, s[36:39], s50 offen sc1
    s_waitcnt lgkmcnt(0)
    buffer_store_dwordx4 v[140:143], v183, s[36:39], s50 offen sc1
L_fin:
L_end:
    s_endpgm

.section .rodata,"a"
.p2align 6
.amdhsa_kernel standalone__detection_seg_fpn_lateral__vision_kernel
  .amdhsa_next_free_vgpr 512
  .amdhsa_next_free_sgpr 102
  .amdhsa_accum_offset 256
  .amdhsa_group_segment_fixed_size 0
  .amdhsa_kernarg_size 56
  .amdhsa_user_sgpr_count 2
  .amdhsa_user_sgpr_kernarg_segment_ptr 1
  .amdhsa_system_sgpr_workgroup_id_x 1
.end_amdhsa_kernel
```
